```python
import torch

def _softmax(x, axis=-1):
    return torch.softmax(x, dim=axis)
def _gelu(x):
    return torch.nn.functional.gelu(x, approximate="tanh")
def _silu(x):
    return torch.nn.functional.silu(x)
def _sigmoid(x):
    return torch.sigmoid(x)
def _layernorm(x, axis=-1, eps=1e-5):
    m = x.mean(dim=axis, keepdim=True)
    v = x.var(dim=axis, keepdim=True, unbiased=False)
    return (x - m) / torch.sqrt(v + eps)
def _scatter_add(tgt, idx, src, axis=0):
    return tgt.clone().index_add_(axis, idx, src)
def _segment_sum(src, seg, n):
    out = torch.zeros((n,) + src.shape[1:], dtype=src.dtype)
    return out.index_add_(0, seg, src)
def _pad(x, pw):
    flat = tuple(v for pair in reversed(pw) for v in pair)
    return torch.nn.functional.pad(x, flat)

kernel_name = 'sequential_preLN__spectral_fnet__glu_gated_glu__prompt'

def setup_inputs():

    _w = (lambda a: (lambda t: t.to(torch.bfloat16) if t.is_floating_point() else t)(torch.as_tensor(a)))
    def _A_setup():
        B, S, D = 1, 2048, 640
        ns = torch.arange(S)[:, None] * torch.arange(S)[None, :]
        nd = torch.arange(D)[:, None] * torch.arange(D)[None, :]
        Ws_re = torch.cos(-2.0 * torch.pi * ns / S).to(float)
        Ws_im = torch.sin(-2.0 * torch.pi * ns / S).to(float)
        Wd_re = torch.cos(-2.0 * torch.pi * nd / D).to(float)
        Wd_im = torch.sin(-2.0 * torch.pi * nd / D).to(float)
        return {
            "x": _w((lambda *s: torch.randn(*s, dtype=torch.bfloat16) * 0.05)(B, S, D)),
            "dft_seq_re": _w(Ws_re),
            "dft_seq_im": _w(Ws_im),
            "dft_hid_re": _w(Wd_re),
            "dft_hid_im": _w(Wd_im),
        }
    _A_in = _A_setup()

    def _B_setup():
        B, S, D, F = 1, 2048, 640, 1728
        return {
            "x": _w((lambda *s: torch.randn(*s, dtype=torch.bfloat16) * 0.05)(B, S, D)),
            "w_gate": _w((lambda *s: torch.randn(*s, dtype=torch.bfloat16) * 1.6)(D, F)),
            "w_up": _w((lambda *s: torch.randn(*s, dtype=torch.bfloat16) * 0.8)(D, F)),
            "w_down": _w((lambda *s: torch.randn(*s, dtype=torch.bfloat16) * 0.8)(F, D)),
        }
    _B_in = _B_setup()

    return {
        "A_x": _A_in["x"],
        "A_dft_seq_re": _A_in["dft_seq_re"],
        "A_dft_seq_im": _A_in["dft_seq_im"],
        "A_dft_hid_re": _A_in["dft_hid_re"],
        "A_dft_hid_im": _A_in["dft_hid_im"],
        "B_x": _B_in["x"],
        "B_w_gate": _B_in["w_gate"],
        "B_w_up": _B_in["w_up"],
        "B_w_down": _B_in["w_down"],
    }

def reference(A_x, A_dft_seq_re, A_dft_seq_im, A_dft_hid_re, A_dft_hid_im, B_x, B_w_gate, B_w_up, B_w_down):
    def _A_ref(x, dft_seq_re, dft_seq_im, dft_hid_re, dft_hid_im):
        a = torch.einsum("bsd,ed->bse", x, dft_hid_re)
        b = torch.einsum("bsd,ed->bse", x, dft_hid_im)
        y = torch.einsum("ts,bse->bte", dft_seq_re, a) - torch.einsum("ts,bse->bte", dft_seq_im, b)
        return y

    def _B_ref(x, w_gate, w_up, w_down):
        g = torch.einsum("bsd,df->bsf", x, w_gate)
        u = torch.einsum("bsd,df->bsf", x, w_up)
        h = _sigmoid(g) * u
        return torch.einsum("bsf,fd->bsd", h, w_down)

    x = A_x
    h = x + _A_ref(_layernorm(x, axis=-1), A_dft_seq_re, A_dft_seq_im, A_dft_hid_re, A_dft_hid_im)
    h2 = h + _B_ref(_layernorm(h, axis=-1), B_w_gate, B_w_up, B_w_down)
    return h2
```

```asm
; @launch kernel=ka_kernel grid=(661,1,1) block=(256,1,1) lds=19456
; @launch kernel=kb_kernel grid=(256,1,1) block=(320,1,1) lds=97280
; @launch kernel=kc_kernel grid=(256,1,1) block=(256,1,1) lds=143360
; @launch kernel=kd_kernel grid=(256,1,1) block=(256,1,1) lds=61440
.amdgcn_target "amdgcn-amd-amdhsa--gfx950"
.text
.globl ka_kernel
.p2align 8
.type ka_kernel,@function
ka_kernel:

    s_cmp_ge_u32 s2, 256
    s_cbranch_scc1 L_ka_prep
    s_load_dwordx2 s[4:5], s[0:1], 0
    s_load_dwordx2 s[10:11], s[0:1], 88
    s_getpc_b64 s[20:21]
L_ka_pc:
    s_add_u32 s20, s20, T_ka-L_ka_pc
    s_addc_u32 s21, s21, 0
    v_lshrrev_b32 v1, 6, v0
    v_and_b32 v2, 63, v0
    v_readfirstlane_b32 s6, v1
    v_lshrrev_b32 v3, 4, v2
    v_and_b32 v4, 15, v2
    s_and_b32 s7, s2, 7
    s_lshr_b32 s8, s2, 3
    s_lshr_b32 s9, s8, 3
    s_lshl_b32 s9, s9, 3
    s_add_u32 s7, s7, s9
    s_and_b32 s8, s8, 7
    v_lshlrev_b32 v7, 4, v0
    v_lshlrev_b32 v8, 10, v1
    v_add_u32 v7, v7, v8
    global_load_dwordx4 v[128:131], v7, s[20:21]
    global_load_dwordx4 v[132:135], v7, s[20:21] offset:1024
    s_lshl_b32 s9, s6, 9
    s_add_u32 s9, s9, s7
    v_lshlrev_b32 v5, 5, v3
    v_add_u32 v5, s9, v5
    v_mul_u32_u24 v5, 1280, v5
    v_min_u32 v9, 9, v4
    v_lshlrev_b32 v9, 4, v9
    s_mul_i32 s9, s8, 160
    v_add3_u32 v6, v5, v9, s9
    v_lshl_add_u32 v5, v4, 4, v5
    s_mov_b32 s24, 0
    s_mov_b32 s25, 163840
    s_mov_b32 s26, 327680
    s_mov_b32 s27, 491520
    s_waitcnt lgkmcnt(0)
    s_mov_b32 s12, s4
    s_mov_b32 s13, s5
    s_mov_b32 s14, 2621440
    s_mov_b32 s15, 0x00020000
    s_mov_b32 s16, s10
    s_mov_b32 s17, s11
    s_mov_b32 s18, 2621440
    s_mov_b32 s19, 0x00020000
    buffer_load_dwordx4 v[32:35], v5, s[12:15], s24 offen offset:0
    buffer_load_dwordx4 v[36:39], v5, s[12:15], s24 offen offset:256
    buffer_load_dwordx4 v[40:43], v5, s[12:15], s24 offen offset:512
    buffer_load_dwordx4 v[44:47], v5, s[12:15], s24 offen offset:768
    buffer_load_dwordx4 v[48:51], v5, s[12:15], s24 offen offset:1024
    buffer_load_dwordx4 v[52:55], v5, s[12:15], s25 offen offset:0
    buffer_load_dwordx4 v[56:59], v5, s[12:15], s25 offen offset:256
    buffer_load_dwordx4 v[60:63], v5, s[12:15], s25 offen offset:512
    buffer_load_dwordx4 v[64:67], v5, s[12:15], s25 offen offset:768
    buffer_load_dwordx4 v[68:71], v5, s[12:15], s25 offen offset:1024
    buffer_load_dwordx4 v[72:75], v5, s[12:15], s26 offen offset:0
    buffer_load_dwordx4 v[76:79], v5, s[12:15], s26 offen offset:256
    buffer_load_dwordx4 v[80:83], v5, s[12:15], s26 offen offset:512
    buffer_load_dwordx4 v[84:87], v5, s[12:15], s26 offen offset:768
    buffer_load_dwordx4 v[88:91], v5, s[12:15], s26 offen offset:1024
    buffer_load_dwordx4 v[92:95], v5, s[12:15], s27 offen offset:0
    buffer_load_dwordx4 v[96:99], v5, s[12:15], s27 offen offset:256
    buffer_load_dwordx4 v[100:103], v5, s[12:15], s27 offen offset:512
    buffer_load_dwordx4 v[104:107], v5, s[12:15], s27 offen offset:768
    buffer_load_dwordx4 v[108:111], v5, s[12:15], s27 offen offset:1024
    buffer_load_dwordx4 v[112:115], v6, s[12:15], s24 offen
    buffer_load_dwordx4 v[116:119], v6, s[12:15], s25 offen
    buffer_load_dwordx4 v[120:123], v6, s[12:15], s26 offen
    buffer_load_dwordx4 v[124:127], v6, s[12:15], s27 offen
    s_mul_i32 s9, s6, 2560
    v_mul_u32_u24 v10, 160, v3
    v_add3_u32 v10, v10, v9, s9
    v_lshrrev_b32 v11, 2, v2
    v_mul_u32_u24 v11, 160, v11
    v_and_b32 v12, 3, v2
    v_lshl_add_u32 v11, v12, 3, v11
    v_lshlrev_b32 v12, 5, v4
    s_lshl_b32 s9, s6, 9
    s_add_u32 s9, s9, s7
    v_add_u32 v12, s9, v12
    v_mul_u32_u24 v12, 1280, v12
    s_mul_i32 s9, s8, 160
    v_lshlrev_b32 v13, 3, v3
    v_add3_u32 v12, v12, v13, s9
    s_mov_b32 s22, 0x3f803f80
    s_mov_b32 s23, 0x3acccccd
    s_mov_b32 s28, 0x3727c5ac
    v_mov_b32 v16, 0
    v_mov_b32 v20, 0
    v_mov_b32 v17, 0
    v_mov_b32 v21, 0
    v_mov_b32 v18, 0
    v_mov_b32 v22, 0
    v_mov_b32 v19, 0
    v_mov_b32 v23, 0
    s_waitcnt vmcnt(19)
    v_dot2c_f32_bf16 v16, s22, v32
    v_dot2c_f32_bf16 v20, v32, v32
    v_dot2c_f32_bf16 v16, s22, v33
    v_dot2c_f32_bf16 v20, v33, v33
    v_dot2c_f32_bf16 v16, s22, v34
    v_dot2c_f32_bf16 v20, v34, v34
    v_dot2c_f32_bf16 v16, s22, v35
    v_dot2c_f32_bf16 v20, v35, v35
    v_dot2c_f32_bf16 v16, s22, v36
    v_dot2c_f32_bf16 v20, v36, v36
    v_dot2c_f32_bf16 v16, s22, v37
    v_dot2c_f32_bf16 v20, v37, v37
    v_dot2c_f32_bf16 v16, s22, v38
    v_dot2c_f32_bf16 v20, v38, v38
    v_dot2c_f32_bf16 v16, s22, v39
    v_dot2c_f32_bf16 v20, v39, v39
    v_dot2c_f32_bf16 v16, s22, v40
    v_dot2c_f32_bf16 v20, v40, v40
    v_dot2c_f32_bf16 v16, s22, v41
    v_dot2c_f32_bf16 v20, v41, v41
    v_dot2c_f32_bf16 v16, s22, v42
    v_dot2c_f32_bf16 v20, v42, v42
    v_dot2c_f32_bf16 v16, s22, v43
    v_dot2c_f32_bf16 v20, v43, v43
    v_dot2c_f32_bf16 v16, s22, v44
    v_dot2c_f32_bf16 v20, v44, v44
    v_dot2c_f32_bf16 v16, s22, v45
    v_dot2c_f32_bf16 v20, v45, v45
    v_dot2c_f32_bf16 v16, s22, v46
    v_dot2c_f32_bf16 v20, v46, v46
    v_dot2c_f32_bf16 v16, s22, v47
    v_dot2c_f32_bf16 v20, v47, v47
    v_dot2c_f32_bf16 v16, s22, v48
    v_dot2c_f32_bf16 v20, v48, v48
    v_dot2c_f32_bf16 v16, s22, v49
    v_dot2c_f32_bf16 v20, v49, v49
    v_dot2c_f32_bf16 v16, s22, v50
    v_dot2c_f32_bf16 v20, v50, v50
    v_dot2c_f32_bf16 v16, s22, v51
    v_dot2c_f32_bf16 v20, v51, v51
    s_waitcnt vmcnt(14)
    v_dot2c_f32_bf16 v17, s22, v52
    v_dot2c_f32_bf16 v21, v52, v52
    v_dot2c_f32_bf16 v17, s22, v53
    v_dot2c_f32_bf16 v21, v53, v53
    v_dot2c_f32_bf16 v17, s22, v54
    v_dot2c_f32_bf16 v21, v54, v54
    v_dot2c_f32_bf16 v17, s22, v55
    v_dot2c_f32_bf16 v21, v55, v55
    v_dot2c_f32_bf16 v17, s22, v56
    v_dot2c_f32_bf16 v21, v56, v56
    v_dot2c_f32_bf16 v17, s22, v57
    v_dot2c_f32_bf16 v21, v57, v57
    v_dot2c_f32_bf16 v17, s22, v58
    v_dot2c_f32_bf16 v21, v58, v58
    v_dot2c_f32_bf16 v17, s22, v59
    v_dot2c_f32_bf16 v21, v59, v59
    v_dot2c_f32_bf16 v17, s22, v60
    v_dot2c_f32_bf16 v21, v60, v60
    v_dot2c_f32_bf16 v17, s22, v61
    v_dot2c_f32_bf16 v21, v61, v61
    v_dot2c_f32_bf16 v17, s22, v62
    v_dot2c_f32_bf16 v21, v62, v62
    v_dot2c_f32_bf16 v17, s22, v63
    v_dot2c_f32_bf16 v21, v63, v63
    v_dot2c_f32_bf16 v17, s22, v64
    v_dot2c_f32_bf16 v21, v64, v64
    v_dot2c_f32_bf16 v17, s22, v65
    v_dot2c_f32_bf16 v21, v65, v65
    v_dot2c_f32_bf16 v17, s22, v66
    v_dot2c_f32_bf16 v21, v66, v66
    v_dot2c_f32_bf16 v17, s22, v67
    v_dot2c_f32_bf16 v21, v67, v67
    v_dot2c_f32_bf16 v17, s22, v68
    v_dot2c_f32_bf16 v21, v68, v68
    v_dot2c_f32_bf16 v17, s22, v69
    v_dot2c_f32_bf16 v21, v69, v69
    v_dot2c_f32_bf16 v17, s22, v70
    v_dot2c_f32_bf16 v21, v70, v70
    v_dot2c_f32_bf16 v17, s22, v71
    v_dot2c_f32_bf16 v21, v71, v71
    s_waitcnt vmcnt(9)
    v_dot2c_f32_bf16 v18, s22, v72
    v_dot2c_f32_bf16 v22, v72, v72
    v_dot2c_f32_bf16 v18, s22, v73
    v_dot2c_f32_bf16 v22, v73, v73
    v_dot2c_f32_bf16 v18, s22, v74
    v_dot2c_f32_bf16 v22, v74, v74
    v_dot2c_f32_bf16 v18, s22, v75
    v_dot2c_f32_bf16 v22, v75, v75
    v_dot2c_f32_bf16 v18, s22, v76
    v_dot2c_f32_bf16 v22, v76, v76
    v_dot2c_f32_bf16 v18, s22, v77
    v_dot2c_f32_bf16 v22, v77, v77
    v_dot2c_f32_bf16 v18, s22, v78
    v_dot2c_f32_bf16 v22, v78, v78
    v_dot2c_f32_bf16 v18, s22, v79
    v_dot2c_f32_bf16 v22, v79, v79
    v_dot2c_f32_bf16 v18, s22, v80
    v_dot2c_f32_bf16 v22, v80, v80
    v_dot2c_f32_bf16 v18, s22, v81
    v_dot2c_f32_bf16 v22, v81, v81
    v_dot2c_f32_bf16 v18, s22, v82
    v_dot2c_f32_bf16 v22, v82, v82
    v_dot2c_f32_bf16 v18, s22, v83
    v_dot2c_f32_bf16 v22, v83, v83
    v_dot2c_f32_bf16 v18, s22, v84
    v_dot2c_f32_bf16 v22, v84, v84
    v_dot2c_f32_bf16 v18, s22, v85
    v_dot2c_f32_bf16 v22, v85, v85
    v_dot2c_f32_bf16 v18, s22, v86
    v_dot2c_f32_bf16 v22, v86, v86
    v_dot2c_f32_bf16 v18, s22, v87
    v_dot2c_f32_bf16 v22, v87, v87
    v_dot2c_f32_bf16 v18, s22, v88
    v_dot2c_f32_bf16 v22, v88, v88
    v_dot2c_f32_bf16 v18, s22, v89
    v_dot2c_f32_bf16 v22, v89, v89
    v_dot2c_f32_bf16 v18, s22, v90
    v_dot2c_f32_bf16 v22, v90, v90
    v_dot2c_f32_bf16 v18, s22, v91
    v_dot2c_f32_bf16 v22, v91, v91
    s_waitcnt vmcnt(4)
    v_dot2c_f32_bf16 v19, s22, v92
    v_dot2c_f32_bf16 v23, v92, v92
    v_dot2c_f32_bf16 v19, s22, v93
    v_dot2c_f32_bf16 v23, v93, v93
    v_dot2c_f32_bf16 v19, s22, v94
    v_dot2c_f32_bf16 v23, v94, v94
    v_dot2c_f32_bf16 v19, s22, v95
    v_dot2c_f32_bf16 v23, v95, v95
    v_dot2c_f32_bf16 v19, s22, v96
    v_dot2c_f32_bf16 v23, v96, v96
    v_dot2c_f32_bf16 v19, s22, v97
    v_dot2c_f32_bf16 v23, v97, v97
    v_dot2c_f32_bf16 v19, s22, v98
    v_dot2c_f32_bf16 v23, v98, v98
    v_dot2c_f32_bf16 v19, s22, v99
    v_dot2c_f32_bf16 v23, v99, v99
    v_dot2c_f32_bf16 v19, s22, v100
    v_dot2c_f32_bf16 v23, v100, v100
    v_dot2c_f32_bf16 v19, s22, v101
    v_dot2c_f32_bf16 v23, v101, v101
    v_dot2c_f32_bf16 v19, s22, v102
    v_dot2c_f32_bf16 v23, v102, v102
    v_dot2c_f32_bf16 v19, s22, v103
    v_dot2c_f32_bf16 v23, v103, v103
    v_dot2c_f32_bf16 v19, s22, v104
    v_dot2c_f32_bf16 v23, v104, v104
    v_dot2c_f32_bf16 v19, s22, v105
    v_dot2c_f32_bf16 v23, v105, v105
    v_dot2c_f32_bf16 v19, s22, v106
    v_dot2c_f32_bf16 v23, v106, v106
    v_dot2c_f32_bf16 v19, s22, v107
    v_dot2c_f32_bf16 v23, v107, v107
    v_dot2c_f32_bf16 v19, s22, v108
    v_dot2c_f32_bf16 v23, v108, v108
    v_dot2c_f32_bf16 v19, s22, v109
    v_dot2c_f32_bf16 v23, v109, v109
    v_dot2c_f32_bf16 v19, s22, v110
    v_dot2c_f32_bf16 v23, v110, v110
    v_dot2c_f32_bf16 v19, s22, v111
    v_dot2c_f32_bf16 v23, v111, v111
    v_add_f32_dpp v16, v16, v16 row_ror:8 row_mask:0xf bank_mask:0xf
    v_add_f32_dpp v17, v17, v17 row_ror:8 row_mask:0xf bank_mask:0xf
    v_add_f32_dpp v18, v18, v18 row_ror:8 row_mask:0xf bank_mask:0xf
    v_add_f32_dpp v19, v19, v19 row_ror:8 row_mask:0xf bank_mask:0xf
    v_add_f32_dpp v20, v20, v20 row_ror:8 row_mask:0xf bank_mask:0xf
    v_add_f32_dpp v21, v21, v21 row_ror:8 row_mask:0xf bank_mask:0xf
    v_add_f32_dpp v22, v22, v22 row_ror:8 row_mask:0xf bank_mask:0xf
    v_add_f32_dpp v23, v23, v23 row_ror:8 row_mask:0xf bank_mask:0xf
    v_add_f32_dpp v16, v16, v16 row_ror:4 row_mask:0xf bank_mask:0xf
    v_add_f32_dpp v17, v17, v17 row_ror:4 row_mask:0xf bank_mask:0xf
    v_add_f32_dpp v18, v18, v18 row_ror:4 row_mask:0xf bank_mask:0xf
    v_add_f32_dpp v19, v19, v19 row_ror:4 row_mask:0xf bank_mask:0xf
    v_add_f32_dpp v20, v20, v20 row_ror:4 row_mask:0xf bank_mask:0xf
    v_add_f32_dpp v21, v21, v21 row_ror:4 row_mask:0xf bank_mask:0xf
    v_add_f32_dpp v22, v22, v22 row_ror:4 row_mask:0xf bank_mask:0xf
    v_add_f32_dpp v23, v23, v23 row_ror:4 row_mask:0xf bank_mask:0xf
    v_add_f32_dpp v16, v16, v16 row_ror:2 row_mask:0xf bank_mask:0xf
    v_add_f32_dpp v17, v17, v17 row_ror:2 row_mask:0xf bank_mask:0xf
    v_add_f32_dpp v18, v18, v18 row_ror:2 row_mask:0xf bank_mask:0xf
    v_add_f32_dpp v19, v19, v19 row_ror:2 row_mask:0xf bank_mask:0xf
    v_add_f32_dpp v20, v20, v20 row_ror:2 row_mask:0xf bank_mask:0xf
    v_add_f32_dpp v21, v21, v21 row_ror:2 row_mask:0xf bank_mask:0xf
    v_add_f32_dpp v22, v22, v22 row_ror:2 row_mask:0xf bank_mask:0xf
    v_add_f32_dpp v23, v23, v23 row_ror:2 row_mask:0xf bank_mask:0xf
    v_add_f32_dpp v16, v16, v16 row_ror:1 row_mask:0xf bank_mask:0xf
    v_add_f32_dpp v17, v17, v17 row_ror:1 row_mask:0xf bank_mask:0xf
    v_add_f32_dpp v18, v18, v18 row_ror:1 row_mask:0xf bank_mask:0xf
    v_add_f32_dpp v19, v19, v19 row_ror:1 row_mask:0xf bank_mask:0xf
    v_add_f32_dpp v20, v20, v20 row_ror:1 row_mask:0xf bank_mask:0xf
    v_add_f32_dpp v21, v21, v21 row_ror:1 row_mask:0xf bank_mask:0xf
    v_add_f32_dpp v22, v22, v22 row_ror:1 row_mask:0xf bank_mask:0xf
    v_add_f32_dpp v23, v23, v23 row_ror:1 row_mask:0xf bank_mask:0xf
    v_mul_f32 v16, s23, v16
    v_mul_f32 v20, s23, v20
    v_mul_f32 v17, s23, v17
    v_mul_f32 v21, s23, v21
    v_mul_f32 v18, s23, v18
    v_mul_f32 v22, s23, v22
    v_mul_f32 v19, s23, v19
    v_mul_f32 v23, s23, v23
    v_fma_f32 v20, -v16, v16, v20
    v_fma_f32 v21, -v17, v17, v21
    v_fma_f32 v22, -v18, v18, v22
    v_fma_f32 v23, -v19, v19, v23
    v_max_f32 v20, 0, v20
    v_max_f32 v21, 0, v21
    v_max_f32 v22, 0, v22
    v_max_f32 v23, 0, v23
    v_cvt_pk_bf16_f32 v16, v16, v16
    v_lshlrev_b32 v16, 16, v16
    v_cvt_pk_bf16_f32 v17, v17, v17
    v_lshlrev_b32 v17, 16, v17
    v_cvt_pk_bf16_f32 v18, v18, v18
    v_lshlrev_b32 v18, 16, v18
    v_cvt_pk_bf16_f32 v19, v19, v19
    v_lshlrev_b32 v19, 16, v19
    v_cvt_pk_bf16_f32 v20, v20, v20
    v_lshlrev_b32 v20, 16, v20
    v_cvt_pk_bf16_f32 v21, v21, v21
    v_lshlrev_b32 v21, 16, v21
    v_cvt_pk_bf16_f32 v22, v22, v22
    v_lshlrev_b32 v22, 16, v22
    v_cvt_pk_bf16_f32 v23, v23, v23
    v_lshlrev_b32 v23, 16, v23
    v_add_f32 v20, s28, v20
    v_add_f32 v21, s28, v21
    v_add_f32 v22, s28, v22
    v_add_f32 v23, s28, v23
    v_cvt_pk_bf16_f32 v20, v20, v20
    v_lshlrev_b32 v20, 16, v20
    v_cvt_pk_bf16_f32 v21, v21, v21
    v_lshlrev_b32 v21, 16, v21
    v_cvt_pk_bf16_f32 v22, v22, v22
    v_lshlrev_b32 v22, 16, v22
    v_cvt_pk_bf16_f32 v23, v23, v23
    v_lshlrev_b32 v23, 16, v23
    v_sqrt_f32 v20, v20
    v_sqrt_f32 v21, v21
    v_sqrt_f32 v22, v22
    v_sqrt_f32 v23, v23
    v_cvt_pk_bf16_f32 v20, v20, v20
    v_lshlrev_b32 v20, 16, v20
    v_cvt_pk_bf16_f32 v21, v21, v21
    v_lshlrev_b32 v21, 16, v21
    v_cvt_pk_bf16_f32 v22, v22, v22
    v_lshlrev_b32 v22, 16, v22
    v_cvt_pk_bf16_f32 v23, v23, v23
    v_lshlrev_b32 v23, 16, v23
    v_rcp_f32 v20, v20
    v_rcp_f32 v21, v21
    v_rcp_f32 v22, v22
    v_rcp_f32 v23, v23
    s_waitcnt vmcnt(3)
    v_lshlrev_b32 v32, 16, v112
    v_and_b32 v33, 0xffff0000, v112
    v_lshlrev_b32 v34, 16, v113
    v_and_b32 v35, 0xffff0000, v113
    v_lshlrev_b32 v36, 16, v114
    v_and_b32 v37, 0xffff0000, v114
    v_lshlrev_b32 v38, 16, v115
    v_and_b32 v39, 0xffff0000, v115
    v_sub_f32 v32, v32, v16
    v_sub_f32 v33, v33, v16
    v_sub_f32 v34, v34, v16
    v_sub_f32 v35, v35, v16
    v_sub_f32 v36, v36, v16
    v_sub_f32 v37, v37, v16
    v_sub_f32 v38, v38, v16
    v_sub_f32 v39, v39, v16
    v_cvt_pk_bf16_f32 v40, v32, v33
    v_cvt_pk_bf16_f32 v41, v34, v35
    v_cvt_pk_bf16_f32 v42, v36, v37
    v_cvt_pk_bf16_f32 v43, v38, v39
    v_lshlrev_b32 v32, 16, v40
    v_and_b32 v33, 0xffff0000, v40
    v_lshlrev_b32 v34, 16, v41
    v_and_b32 v35, 0xffff0000, v41
    v_lshlrev_b32 v36, 16, v42
    v_and_b32 v37, 0xffff0000, v42
    v_lshlrev_b32 v38, 16, v43
    v_and_b32 v39, 0xffff0000, v43
    v_mul_f32 v32, v32, v20
    v_mul_f32 v33, v33, v20
    v_mul_f32 v34, v34, v20
    v_mul_f32 v35, v35, v20
    v_mul_f32 v36, v36, v20
    v_mul_f32 v37, v37, v20
    v_mul_f32 v38, v38, v20
    v_mul_f32 v39, v39, v20
    v_cvt_pk_bf16_f32 v40, v32, v33
    v_cvt_pk_bf16_f32 v41, v34, v35
    v_cvt_pk_bf16_f32 v42, v36, v37
    v_cvt_pk_bf16_f32 v43, v38, v39
    v_lshlrev_b32 v32, 16, v40
    v_and_b32 v33, 0xffff0000, v40
    v_lshlrev_b32 v34, 16, v41
    v_and_b32 v35, 0xffff0000, v41
    v_lshlrev_b32 v36, 16, v42
    v_and_b32 v37, 0xffff0000, v42
    v_lshlrev_b32 v38, 16, v43
    v_and_b32 v39, 0xffff0000, v43
    v_cvt_pk_f16_f32 v40, v32, v33
    v_cvt_pk_f16_f32 v41, v34, v35
    v_cvt_pk_f16_f32 v42, v36, v37
    v_cvt_pk_f16_f32 v43, v38, v39
    ds_write_b128 v10, v[40:43] offset:0
    s_waitcnt vmcnt(2)
    v_lshlrev_b32 v48, 16, v116
    v_and_b32 v49, 0xffff0000, v116
    v_lshlrev_b32 v50, 16, v117
    v_and_b32 v51, 0xffff0000, v117
    v_lshlrev_b32 v52, 16, v118
    v_and_b32 v53, 0xffff0000, v118
    v_lshlrev_b32 v54, 16, v119
    v_and_b32 v55, 0xffff0000, v119
    v_sub_f32 v48, v48, v17
    v_sub_f32 v49, v49, v17
    v_sub_f32 v50, v50, v17
    v_sub_f32 v51, v51, v17
    v_sub_f32 v52, v52, v17
    v_sub_f32 v53, v53, v17
    v_sub_f32 v54, v54, v17
    v_sub_f32 v55, v55, v17
    v_cvt_pk_bf16_f32 v56, v48, v49
    v_cvt_pk_bf16_f32 v57, v50, v51
    v_cvt_pk_bf16_f32 v58, v52, v53
    v_cvt_pk_bf16_f32 v59, v54, v55
    v_lshlrev_b32 v48, 16, v56
    v_and_b32 v49, 0xffff0000, v56
    v_lshlrev_b32 v50, 16, v57
    v_and_b32 v51, 0xffff0000, v57
    v_lshlrev_b32 v52, 16, v58
    v_and_b32 v53, 0xffff0000, v58
    v_lshlrev_b32 v54, 16, v59
    v_and_b32 v55, 0xffff0000, v59
    v_mul_f32 v48, v48, v21
    v_mul_f32 v49, v49, v21
    v_mul_f32 v50, v50, v21
    v_mul_f32 v51, v51, v21
    v_mul_f32 v52, v52, v21
    v_mul_f32 v53, v53, v21
    v_mul_f32 v54, v54, v21
    v_mul_f32 v55, v55, v21
    v_cvt_pk_bf16_f32 v56, v48, v49
    v_cvt_pk_bf16_f32 v57, v50, v51
    v_cvt_pk_bf16_f32 v58, v52, v53
    v_cvt_pk_bf16_f32 v59, v54, v55
    v_lshlrev_b32 v48, 16, v56
    v_and_b32 v49, 0xffff0000, v56
    v_lshlrev_b32 v50, 16, v57
    v_and_b32 v51, 0xffff0000, v57
    v_lshlrev_b32 v52, 16, v58
    v_and_b32 v53, 0xffff0000, v58
    v_lshlrev_b32 v54, 16, v59
    v_and_b32 v55, 0xffff0000, v59
    v_cvt_pk_f16_f32 v56, v48, v49
    v_cvt_pk_f16_f32 v57, v50, v51
    v_cvt_pk_f16_f32 v58, v52, v53
    v_cvt_pk_f16_f32 v59, v54, v55
    ds_write_b128 v10, v[56:59] offset:640
    s_waitcnt vmcnt(1)
    v_lshlrev_b32 v64, 16, v120
    v_and_b32 v65, 0xffff0000, v120
    v_lshlrev_b32 v66, 16, v121
    v_and_b32 v67, 0xffff0000, v121
    v_lshlrev_b32 v68, 16, v122
    v_and_b32 v69, 0xffff0000, v122
    v_lshlrev_b32 v70, 16, v123
    v_and_b32 v71, 0xffff0000, v123
    v_sub_f32 v64, v64, v18
    v_sub_f32 v65, v65, v18
    v_sub_f32 v66, v66, v18
    v_sub_f32 v67, v67, v18
    v_sub_f32 v68, v68, v18
    v_sub_f32 v69, v69, v18
    v_sub_f32 v70, v70, v18
    v_sub_f32 v71, v71, v18
    v_cvt_pk_bf16_f32 v72, v64, v65
    v_cvt_pk_bf16_f32 v73, v66, v67
    v_cvt_pk_bf16_f32 v74, v68, v69
    v_cvt_pk_bf16_f32 v75, v70, v71
    v_lshlrev_b32 v64, 16, v72
    v_and_b32 v65, 0xffff0000, v72
    v_lshlrev_b32 v66, 16, v73
    v_and_b32 v67, 0xffff0000, v73
    v_lshlrev_b32 v68, 16, v74
    v_and_b32 v69, 0xffff0000, v74
    v_lshlrev_b32 v70, 16, v75
    v_and_b32 v71, 0xffff0000, v75
    v_mul_f32 v64, v64, v22
    v_mul_f32 v65, v65, v22
    v_mul_f32 v66, v66, v22
    v_mul_f32 v67, v67, v22
    v_mul_f32 v68, v68, v22
    v_mul_f32 v69, v69, v22
    v_mul_f32 v70, v70, v22
    v_mul_f32 v71, v71, v22
    v_cvt_pk_bf16_f32 v72, v64, v65
    v_cvt_pk_bf16_f32 v73, v66, v67
    v_cvt_pk_bf16_f32 v74, v68, v69
    v_cvt_pk_bf16_f32 v75, v70, v71
    v_lshlrev_b32 v64, 16, v72
    v_and_b32 v65, 0xffff0000, v72
    v_lshlrev_b32 v66, 16, v73
    v_and_b32 v67, 0xffff0000, v73
    v_lshlrev_b32 v68, 16, v74
    v_and_b32 v69, 0xffff0000, v74
    v_lshlrev_b32 v70, 16, v75
    v_and_b32 v71, 0xffff0000, v75
    v_cvt_pk_f16_f32 v72, v64, v65
    v_cvt_pk_f16_f32 v73, v66, v67
    v_cvt_pk_f16_f32 v74, v68, v69
    v_cvt_pk_f16_f32 v75, v70, v71
    ds_write_b128 v10, v[72:75] offset:1280
    s_waitcnt vmcnt(0)
    v_lshlrev_b32 v80, 16, v124
    v_and_b32 v81, 0xffff0000, v124
    v_lshlrev_b32 v82, 16, v125
    v_and_b32 v83, 0xffff0000, v125
    v_lshlrev_b32 v84, 16, v126
    v_and_b32 v85, 0xffff0000, v126
    v_lshlrev_b32 v86, 16, v127
    v_and_b32 v87, 0xffff0000, v127
    v_sub_f32 v80, v80, v19
    v_sub_f32 v81, v81, v19
    v_sub_f32 v82, v82, v19
    v_sub_f32 v83, v83, v19
    v_sub_f32 v84, v84, v19
    v_sub_f32 v85, v85, v19
    v_sub_f32 v86, v86, v19
    v_sub_f32 v87, v87, v19
    v_cvt_pk_bf16_f32 v88, v80, v81
    v_cvt_pk_bf16_f32 v89, v82, v83
    v_cvt_pk_bf16_f32 v90, v84, v85
    v_cvt_pk_bf16_f32 v91, v86, v87
    v_lshlrev_b32 v80, 16, v88
    v_and_b32 v81, 0xffff0000, v88
    v_lshlrev_b32 v82, 16, v89
    v_and_b32 v83, 0xffff0000, v89
    v_lshlrev_b32 v84, 16, v90
    v_and_b32 v85, 0xffff0000, v90
    v_lshlrev_b32 v86, 16, v91
    v_and_b32 v87, 0xffff0000, v91
    v_mul_f32 v80, v80, v23
    v_mul_f32 v81, v81, v23
    v_mul_f32 v82, v82, v23
    v_mul_f32 v83, v83, v23
    v_mul_f32 v84, v84, v23
    v_mul_f32 v85, v85, v23
    v_mul_f32 v86, v86, v23
    v_mul_f32 v87, v87, v23
    v_cvt_pk_bf16_f32 v88, v80, v81
    v_cvt_pk_bf16_f32 v89, v82, v83
    v_cvt_pk_bf16_f32 v90, v84, v85
    v_cvt_pk_bf16_f32 v91, v86, v87
    v_lshlrev_b32 v80, 16, v88
    v_and_b32 v81, 0xffff0000, v88
    v_lshlrev_b32 v82, 16, v89
    v_and_b32 v83, 0xffff0000, v89
    v_lshlrev_b32 v84, 16, v90
    v_and_b32 v85, 0xffff0000, v90
    v_lshlrev_b32 v86, 16, v91
    v_and_b32 v87, 0xffff0000, v91
    v_cvt_pk_f16_f32 v88, v80, v81
    v_cvt_pk_f16_f32 v89, v82, v83
    v_cvt_pk_f16_f32 v90, v84, v85
    v_cvt_pk_f16_f32 v91, v86, v87
    ds_write_b128 v10, v[88:91] offset:1920
    s_waitcnt lgkmcnt(0)
    s_barrier
    ds_read_b64_tr_b16 v[32:33], v11 offset:0
    ds_read_b64_tr_b16 v[34:35], v11 offset:2560
    ds_read_b64_tr_b16 v[36:37], v11 offset:5120
    ds_read_b64_tr_b16 v[38:39], v11 offset:7680
    ds_read_b64_tr_b16 v[40:41], v11 offset:32
    ds_read_b64_tr_b16 v[42:43], v11 offset:2592
    ds_read_b64_tr_b16 v[44:45], v11 offset:5152
    ds_read_b64_tr_b16 v[46:47], v11 offset:7712
    ds_read_b64_tr_b16 v[48:49], v11 offset:64
    ds_read_b64_tr_b16 v[50:51], v11 offset:2624
    ds_read_b64_tr_b16 v[52:53], v11 offset:5184
    ds_read_b64_tr_b16 v[54:55], v11 offset:7744
    ds_read_b64_tr_b16 v[56:57], v11 offset:96
    ds_read_b64_tr_b16 v[58:59], v11 offset:2656
    ds_read_b64_tr_b16 v[60:61], v11 offset:5216
    ds_read_b64_tr_b16 v[62:63], v11 offset:7776
    ds_read_b64_tr_b16 v[64:65], v11 offset:128
    ds_read_b64_tr_b16 v[66:67], v11 offset:2688
    ds_read_b64_tr_b16 v[68:69], v11 offset:5248
    ds_read_b64_tr_b16 v[70:71], v11 offset:7808
    s_waitcnt lgkmcnt(15)
    v_mfma_f32_16x16x32_f16 v[80:83], v[32:35], v[128:131], 0
    v_mfma_f32_16x16x32_f16 v[80:83], v[36:39], v[132:135], v[80:83]
    s_waitcnt lgkmcnt(12)
    v_mfma_f32_16x16x32_f16 v[84:87], v[40:43], v[128:131], 0
    v_mfma_f32_16x16x32_f16 v[84:87], v[44:47], v[132:135], v[84:87]
    s_waitcnt lgkmcnt(8)
    v_mfma_f32_16x16x32_f16 v[88:91], v[48:51], v[128:131], 0
    v_mfma_f32_16x16x32_f16 v[88:91], v[52:55], v[132:135], v[88:91]
    s_waitcnt lgkmcnt(4)
    v_mfma_f32_16x16x32_f16 v[92:95], v[56:59], v[128:131], 0
    v_mfma_f32_16x16x32_f16 v[92:95], v[60:63], v[132:135], v[92:95]
    s_waitcnt lgkmcnt(0)
    v_mfma_f32_16x16x32_f16 v[96:99], v[64:67], v[128:131], 0
    v_mfma_f32_16x16x32_f16 v[96:99], v[68:71], v[132:135], v[96:99]
    v_cvt_pk_f16_f32 v100, v80, v81
    v_cvt_pk_f16_f32 v101, v82, v83
    buffer_store_dwordx2 v[100:101], v12, s[16:19], 0 offen offset:0
    v_cvt_pk_f16_f32 v102, v84, v85
    v_cvt_pk_f16_f32 v103, v86, v87
    buffer_store_dwordx2 v[102:103], v12, s[16:19], 0 offen offset:32
    v_cvt_pk_f16_f32 v104, v88, v89
    v_cvt_pk_f16_f32 v105, v90, v91
    buffer_store_dwordx2 v[104:105], v12, s[16:19], 0 offen offset:64
    v_cvt_pk_f16_f32 v106, v92, v93
    v_cvt_pk_f16_f32 v107, v94, v95
    buffer_store_dwordx2 v[106:107], v12, s[16:19], 0 offen offset:96
    v_cvt_pk_f16_f32 v108, v96, v97
    v_cvt_pk_f16_f32 v109, v98, v99
    buffer_store_dwordx2 v[108:109], v12, s[16:19], 0 offen offset:128
    s_branch L_ka_end
L_ka_prep:
    s_cmp_ge_u32 s2, 661
    s_cbranch_scc1 L_ka_end
    s_sub_u32 s3, s2, 256
    s_load_dwordx4 s[4:7], s[0:1], 48
    s_load_dwordx2 s[8:9], s[0:1], 64
    s_load_dwordx2 s[10:11], s[0:1], 88
    v_lshrrev_b32 v1, 6, v0
    v_and_b32 v2, 63, v0
    v_readfirstlane_b32 s12, v1
    s_lshl_b32 s13, s3, 2
    s_add_u32 s13, s13, s12
    s_cmp_ge_u32 s13, 1620
    s_cbranch_scc1 L_ka_end
    s_mul_i32 s14, s12, 4864
    v_lshrrev_b32 v3, 3, v2
    v_and_b32 v4, 7, v2
    v_lshlrev_b32 v4, 4, v4
    v_mul_u32_u24 v5, 144, v3
    v_add_u32 v5, v5, v4
    v_add_u32 v5, s14, v5
    v_lshrrev_b32 v6, 4, v2
    v_bfe_u32 v7, v2, 2, 2
    v_and_b32 v8, 3, v2
    v_lshlrev_b32 v8, 3, v8
    v_lshlrev_b32 v9, 4, v2
    s_waitcnt lgkmcnt(0)
    s_cmp_ge_u32 s13, 1080
    s_cbranch_scc1 L_prep_wdka
    s_mov_b32 s16, s4
    s_mov_b32 s17, s5
    s_mov_b32 s18, 2211840
    s_mov_b32 s19, 0x00020000
    s_mov_b32 s20, s6
    s_mov_b32 s21, s7
    s_mov_b32 s22, 2211840
    s_mov_b32 s23, 0x00020000
    s_add_u32 s24, s10, 7864320
    s_addc_u32 s25, s11, 0
    s_mov_b32 s26, 4423680
    s_mov_b32 s27, 0x00020000
    s_mul_i32 s28, s13, 52429
    s_lshr_b32 s28, s28, 21
    s_mul_i32 s29, s28, 40
    s_sub_u32 s29, s13, s29
    s_mul_i32 s30, s29, 55296
    s_lshl_b32 s31, s28, 7
    s_add_u32 s30, s30, s31
    s_add_u32 s31, s30, 27648
    v_mul_u32_u24 v10, 3456, v3
    v_add_u32 v10, v10, v4
    buffer_load_dwordx4 v[12:15], v10, s[16:19], s30 offen
    buffer_load_dwordx4 v[16:19], v10, s[16:19], s31 offen
    buffer_load_dwordx4 v[20:23], v10, s[20:23], s30 offen
    buffer_load_dwordx4 v[24:27], v10, s[20:23], s31 offen
    v_and_b32 v11, 1, v6
    v_lshlrev_b32 v11, 4, v11
    v_lshrrev_b32 v28, 1, v6
    v_lshlrev_b32 v28, 3, v28
    v_add3_u32 v11, v11, v28, v7
    v_mul_u32_u24 v11, 144, v11
    v_add3_u32 v11, v11, v8, s14
    s_mul_i32 s32, s28, 160
    s_add_u32 s32, s32, s29
    s_lshl_b32 s32, s32, 10
    s_waitcnt vmcnt(0)
    ds_write_b128 v5, v[12:15]
    ds_write_b128 v5, v[16:19] offset:1152
    ds_write_b128 v5, v[20:23] offset:2304
    ds_write_b128 v5, v[24:27] offset:3456
    s_waitcnt lgkmcnt(0)
    ds_read_b64_tr_b16 v[12:13], v11 offset:0
    ds_read_b64_tr_b16 v[14:15], v11 offset:576
    ds_read_b64_tr_b16 v[16:17], v11 offset:32
    ds_read_b64_tr_b16 v[18:19], v11 offset:608
    ds_read_b64_tr_b16 v[20:21], v11 offset:64
    ds_read_b64_tr_b16 v[22:23], v11 offset:640
    ds_read_b64_tr_b16 v[24:25], v11 offset:96
    ds_read_b64_tr_b16 v[26:27], v11 offset:672
    s_waitcnt lgkmcnt(6)
    buffer_store_dwordx4 v[12:15], v9, s[24:27], s32 offen
    s_add_u32 s32, s32, 40960
    s_waitcnt lgkmcnt(4)
    buffer_store_dwordx4 v[16:19], v9, s[24:27], s32 offen
    s_add_u32 s32, s32, 40960
    s_waitcnt lgkmcnt(2)
    buffer_store_dwordx4 v[20:23], v9, s[24:27], s32 offen
    s_add_u32 s32, s32, 40960
    s_waitcnt lgkmcnt(0)
    buffer_store_dwordx4 v[24:27], v9, s[24:27], s32 offen
    s_branch L_ka_end
L_prep_wdka:
    s_mov_b32 s16, s8
    s_mov_b32 s17, s9
    s_mov_b32 s18, 2211840
    s_mov_b32 s19, 0x00020000
    s_add_u32 s24, s10, 12320768
    s_addc_u32 s25, s11, 0
    s_mov_b32 s26, 2211840
    s_mov_b32 s27, 0x00020000
    s_sub_u32 s13, s13, 1080
    s_mul_i32 s28, s13, 38837
    s_lshr_b32 s28, s28, 21
    s_mul_i32 s29, s28, 54
    s_sub_u32 s29, s13, s29
    s_mul_i32 s30, s29, 40960
    s_lshl_b32 s31, s28, 7
    s_add_u32 s30, s30, s31
    s_add_u32 s31, s30, 10240
    s_add_u32 s33, s30, 20480
    s_add_u32 s34, s30, 30720
    v_mul_u32_u24 v10, 1280, v3
    v_add_u32 v10, v10, v4
    buffer_load_dwordx4 v[12:15], v10, s[16:19], s30 offen
    buffer_load_dwordx4 v[16:19], v10, s[16:19], s31 offen
    buffer_load_dwordx4 v[20:23], v10, s[16:19], s33 offen
    buffer_load_dwordx4 v[24:27], v10, s[16:19], s34 offen
    v_lshrrev_b32 v11, 1, v6
    v_lshlrev_b32 v11, 4, v11
    v_and_b32 v28, 1, v6
    v_lshlrev_b32 v28, 2, v28
    v_add3_u32 v11, v11, v28, v7
    v_mul_u32_u24 v11, 144, v11
    v_add3_u32 v11, v11, v8, s14
    s_mul_i32 s32, s28, 216
    s_add_u32 s32, s32, s29
    s_lshl_b32 s32, s32, 10
    s_waitcnt vmcnt(0)
    ds_write_b128 v5, v[12:15]
    ds_write_b128 v5, v[16:19] offset:1152
    ds_write_b128 v5, v[20:23] offset:2304
    ds_write_b128 v5, v[24:27] offset:3456
    s_waitcnt lgkmcnt(0)
    ds_read_b64_tr_b16 v[12:13], v11 offset:0
    ds_read_b64_tr_b16 v[14:15], v11 offset:1152
    ds_read_b64_tr_b16 v[16:17], v11 offset:32
    ds_read_b64_tr_b16 v[18:19], v11 offset:1184
    ds_read_b64_tr_b16 v[20:21], v11 offset:64
    ds_read_b64_tr_b16 v[22:23], v11 offset:1216
    ds_read_b64_tr_b16 v[24:25], v11 offset:96
    ds_read_b64_tr_b16 v[26:27], v11 offset:1248
    s_waitcnt lgkmcnt(6)
    buffer_store_dwordx4 v[12:15], v9, s[24:27], s32 offen
    s_add_u32 s32, s32, 55296
    s_waitcnt lgkmcnt(4)
    buffer_store_dwordx4 v[16:19], v9, s[24:27], s32 offen
    s_add_u32 s32, s32, 55296
    s_waitcnt lgkmcnt(2)
    buffer_store_dwordx4 v[20:23], v9, s[24:27], s32 offen
    s_add_u32 s32, s32, 55296
    s_waitcnt lgkmcnt(0)
    buffer_store_dwordx4 v[24:27], v9, s[24:27], s32 offen
L_ka_end:
    s_endpgm
.p2align 8
T_ka:
.long 0x3c003c00, 0x3c003c00, 0x3c003c00, 0x3c003c00, 0xbc003c00, 0xbc003c00, 0xbc003c00, 0xbc003c00
.long 0x3bf63c00, 0x3ba83bd9, 0xae460000, 0xb4a5b23e, 0xae468000, 0xb4a5b23e, 0xbbf6bc00, 0xbba8bbd9
.long 0x3bd93c00, 0x3aa73b64, 0xbbd9bc00, 0xbaa7bb64, 0xb23e8000, 0xb872b61f, 0x323e8000, 0x3872361f
.long 0x3ba83c00, 0x39133aa7, 0x34a58000, 0x3a2f3872, 0xb4a58000, 0xba2fb872, 0x3ba83c00, 0x39133aa7
.long 0x3b643c00, 0x361f39a8, 0x3b643c00, 0x361f39a8, 0xb61f8000, 0xbb64b9a8, 0xb61f8000, 0xbb64b9a8
.long 0x3b0e3c00, 0x2e463872, 0xb78b0000, 0xbbf6baa7, 0xb78b8000, 0xbbf6baa7, 0xbb0ebc00, 0xae46b872
.long 0x3aa73c00, 0xb23e361f, 0xbaa7bc00, 0x323eb61f, 0xb8728000, 0xbbd9bb64, 0x38728000, 0x3bd93b64
.long 0x3a2f3c00, 0xb78b323e, 0x39138000, 0x3b0e3bd9, 0xb9138000, 0xbb0ebbd9, 0x3a2f3c00, 0xb78b323e
.long 0x3c003c00, 0x3c003c00, 0x3c003c00, 0x3c003c00, 0xbc003c00, 0xbc003c00, 0xbc003c00, 0xbc003c00
.long 0x3b0e3b64, 0x3a2f3aa7, 0xb78bb61f, 0xb913b872, 0xb78bb61f, 0xb913b872, 0xbb0ebb64, 0xba2fbaa7
.long 0x387239a8, 0x323e361f, 0xb872b9a8, 0xb23eb61f, 0xbaa7b9a8, 0xbbd9bb64, 0x3aa739a8, 0x3bd93b64
.long 0x2e46361f, 0xb78bb23e, 0x3bf63b64, 0x3b0e3bd9, 0xbbf6bb64, 0xbb0ebbd9, 0x2e46361f, 0xb78bb23e
.long 0xb61f0000, 0xbb64b9a8, 0xb61f0000, 0xbb64b9a8, 0xbb64bc00, 0xb61fb9a8, 0xbb64bc00, 0xb61fb9a8
.long 0xba2fb61f, 0xbba8bbd9, 0xb913bb64, 0x34a5b23e, 0xb913bb64, 0x34a5b23e, 0x3a2f361f, 0x3ba83bd9
.long 0xbbd9b9a8, 0xb872bb64, 0x3bd939a8, 0x38723b64, 0xb23eb9a8, 0x3aa7361f, 0x323e39a8, 0xbaa7b61f
.long 0xbba8bb64, 0x2e46b872, 0xb4a5361f, 0xbbf6baa7, 0x34a5b61f, 0x3bf63aa7, 0xbba8bb64, 0x2e46b872
.long 0x3c003c00, 0x3c003c00, 0x3c003c00, 0x3c003c00, 0xbc003c00, 0xbc003c00, 0xbc003c00, 0xbc003c00
.long 0x391339a8, 0x378b3872, 0xba2fb9a8, 0xbb0ebaa7, 0xba2fb9a8, 0xbb0ebaa7, 0xb913b9a8, 0xb78bb872
.long 0xb23e0000, 0xb872b61f, 0x323e8000, 0x3872361f, 0xbbd9bc00, 0xbaa7bb64, 0x3bd93c00, 0x3aa73b64
.long 0xbb0eb9a8, 0xbbf6bbd9, 0x378b39a8, 0xae46323e, 0xb78bb9a8, 0x2e46b23e, 0xbb0eb9a8, 0xbbf6bbd9
.long 0xbb64bc00, 0xb61fb9a8, 0xbb64bc00, 0xb61fb9a8, 0x361f8000, 0x3b6439a8, 0x361f8000, 0x3b6439a8
.long 0xb4a5b9a8, 0x3913323e, 0x3ba839a8, 0x3a2f3bd9, 0x3ba839a8, 0x3a2f3bd9, 0x34a539a8, 0xb913b23e
.long 0x38728000, 0x3bd93b64, 0xb8720000, 0xbbd9bb64, 0x3aa73c00, 0xb23e361f, 0xbaa7bc00, 0x323eb61f
.long 0x3bf639a8, 0x34a53aa7, 0xae46b9a8, 0x3ba83872, 0x2e4639a8, 0xbba8b872, 0x3bf639a8, 0x34a53aa7
.long 0x3c003c00, 0x3c003c00, 0x3c003c00, 0x3c003c00, 0xbc003c00, 0xbc003c00, 0xbc003c00, 0xbc003c00
.long 0x34a5361f, 0x2e46323e, 0xbba8bb64, 0xbbf6bbd9, 0xbba8bb64, 0xbbf6bbd9, 0xb4a5b61f, 0xae46b23e
.long 0xbaa7b9a8, 0xbbd9bb64, 0x3aa739a8, 0x3bd93b64, 0xb872b9a8, 0xb23eb61f, 0x387239a8, 0x323e361f
.long 0xba2fbb64, 0xb4a5b872, 0xb913b61f, 0xbba8baa7, 0x3913361f, 0x3ba83aa7, 0xba2fbb64, 0xb4a5b872
.long 0x361f8000, 0x3b6439a8, 0x361f8000, 0x3b6439a8, 0x3b643c00, 0x361f39a8, 0x3b643c00, 0x361f39a8
.long 0x3bf63b64, 0x378b3aa7, 0xae46361f, 0xbb0eb872, 0xae46361f, 0xbb0eb872, 0xbbf6bb64, 0xb78bbaa7
.long 0x323e39a8, 0xbaa7b61f, 0xb23eb9a8, 0x3aa7361f, 0xbbd9b9a8, 0xb872bb64, 0x3bd939a8, 0x38723b64
.long 0xbb0eb61f, 0xb913bbd9, 0x378b3b64, 0xba2fb23e, 0xb78bbb64, 0x3a2f323e, 0xbb0eb61f, 0xb913bbd9
.long 0x3c003c00, 0x3c003c00, 0x3c003c00, 0x3c003c00, 0xbc003c00, 0xbc003c00, 0xbc003c00, 0xbc003c00
.long 0xbbf6bc00, 0xbba8bbd9, 0x2e468000, 0x34a5323e, 0x2e468000, 0x34a5323e, 0x3bf63c00, 0x3ba83bd9
.long 0x3bd93c00, 0x3aa73b64, 0xbbd9bc00, 0xbaa7bb64, 0xb23e8000, 0xb872b61f, 0x323e8000, 0x3872361f
.long 0xbba8bc00, 0xb913baa7, 0xb4a50000, 0xba2fb872, 0x34a58000, 0x3a2f3872, 0xbba8bc00, 0xb913baa7
.long 0x3b643c00, 0x361f39a8, 0x3b643c00, 0x361f39a8, 0xb61f8000, 0xbb64b9a8, 0xb61f8000, 0xbb64b9a8
.long 0xbb0ebc00, 0xae46b872, 0x378b8000, 0x3bf63aa7, 0x378b8000, 0x3bf63aa7, 0x3b0e3c00, 0x2e463872
.long 0x3aa73c00, 0xb23e361f, 0xbaa7bc00, 0x323eb61f, 0xb8728000, 0xbbd9bb64, 0x38728000, 0x3bd93b64
.long 0xba2fbc00, 0x378bb23e, 0xb9130000, 0xbb0ebbd9, 0x39138000, 0x3b0e3bd9, 0xba2fbc00, 0x378bb23e
.long 0x3c003c00, 0x3c003c00, 0x3c003c00, 0x3c003c00, 0xbc003c00, 0xbc003c00, 0xbc003c00, 0xbc003c00
.long 0xbb0ebb64, 0xba2fbaa7, 0x378b361f, 0x39133872, 0x378b361f, 0x39133872, 0x3b0e3b64, 0x3a2f3aa7
.long 0x387239a8, 0x323e361f, 0xb872b9a8, 0xb23eb61f, 0xbaa7b9a8, 0xbbd9bb64, 0x3aa739a8, 0x3bd93b64
.long 0xae46b61f, 0x378b323e, 0xbbf6bb64, 0xbb0ebbd9, 0x3bf63b64, 0x3b0e3bd9, 0xae46b61f, 0x378b323e
.long 0xb61f0000, 0xbb64b9a8, 0xb61f0000, 0xbb64b9a8, 0xbb64bc00, 0xb61fb9a8, 0xbb64bc00, 0xb61fb9a8
.long 0x3a2f361f, 0x3ba83bd9, 0x39133b64, 0xb4a5323e, 0x39133b64, 0xb4a5323e, 0xba2fb61f, 0xbba8bbd9
.long 0xbbd9b9a8, 0xb872bb64, 0x3bd939a8, 0x38723b64, 0xb23eb9a8, 0x3aa7361f, 0x323e39a8, 0xbaa7b61f
.long 0x3ba83b64, 0xae463872, 0x34a5b61f, 0x3bf63aa7, 0xb4a5361f, 0xbbf6baa7, 0x3ba83b64, 0xae463872
.long 0x3c003c00, 0x3c003c00, 0x3c003c00, 0x3c003c00, 0xbc003c00, 0xbc003c00, 0xbc003c00, 0xbc003c00
.long 0xb913b9a8, 0xb78bb872, 0x3a2f39a8, 0x3b0e3aa7, 0x3a2f39a8, 0x3b0e3aa7, 0x391339a8, 0x378b3872
.long 0xb23e0000, 0xb872b61f, 0x323e8000, 0x3872361f, 0xbbd9bc00, 0xbaa7bb64, 0x3bd93c00, 0x3aa73b64
.long 0x3b0e39a8, 0x3bf63bd9, 0xb78bb9a8, 0x2e46b23e, 0x378b39a8, 0xae46323e, 0x3b0e39a8, 0x3bf63bd9
.long 0xbb64bc00, 0xb61fb9a8, 0xbb64bc00, 0xb61fb9a8, 0x361f8000, 0x3b6439a8, 0x361f8000, 0x3b6439a8
.long 0x34a539a8, 0xb913b23e, 0xbba8b9a8, 0xba2fbbd9, 0xbba8b9a8, 0xba2fbbd9, 0xb4a5b9a8, 0x3913323e
.long 0x38728000, 0x3bd93b64, 0xb8720000, 0xbbd9bb64, 0x3aa73c00, 0xb23e361f, 0xbaa7bc00, 0x323eb61f
.long 0xbbf6b9a8, 0xb4a5baa7, 0x2e4639a8, 0xbba8b872, 0xae46b9a8, 0x3ba83872, 0xbbf6b9a8, 0xb4a5baa7
.long 0x3c003c00, 0x3c003c00, 0x3c003c00, 0x3c003c00, 0xbc003c00, 0xbc003c00, 0xbc003c00, 0xbc003c00
.long 0xb4a5b61f, 0xae46b23e, 0x3ba83b64, 0x3bf63bd9, 0x3ba83b64, 0x3bf63bd9, 0x34a5361f, 0x2e46323e
.long 0xbaa7b9a8, 0xbbd9bb64, 0x3aa739a8, 0x3bd93b64, 0xb872b9a8, 0xb23eb61f, 0x387239a8, 0x323e361f
.long 0x3a2f3b64, 0x34a53872, 0x3913361f, 0x3ba83aa7, 0xb913b61f, 0xbba8baa7, 0x3a2f3b64, 0x34a53872
.long 0x361f8000, 0x3b6439a8, 0x361f8000, 0x3b6439a8, 0x3b643c00, 0x361f39a8, 0x3b643c00, 0x361f39a8
.long 0xbbf6bb64, 0xb78bbaa7, 0x2e46b61f, 0x3b0e3872, 0x2e46b61f, 0x3b0e3872, 0x3bf63b64, 0x378b3aa7
.long 0x323e39a8, 0xbaa7b61f, 0xb23eb9a8, 0x3aa7361f, 0xbbd9b9a8, 0xb872bb64, 0x3bd939a8, 0x38723b64
.long 0x3b0e361f, 0x39133bd9, 0xb78bbb64, 0x3a2f323e, 0x378b3b64, 0xba2fb23e, 0x3b0e361f, 0x39133bd9
.long 0x39a83c00, 0xb9a80000, 0x39a83c00, 0xb9a80000, 0xb9a88000, 0xb9a8bc00, 0xb9a88000, 0xb9a8bc00
.long 0x39133c00, 0xbb0eb23e, 0xba2f0000, 0xb78bbbd9, 0xba2f8000, 0xb78bbbd9, 0xb913bc00, 0x3b0e323e
.long 0x38723c00, 0xbbd9b61f, 0xb872bc00, 0x3bd9361f, 0xbaa78000, 0xb23ebb64, 0x3aa78000, 0x323e3b64
.long 0x378b3c00, 0xbbf6b872, 0x3b0e8000, 0xae463aa7, 0xbb0e8000, 0x2e46baa7, 0x378b3c00, 0xbbf6b872
.long 0x361f3c00, 0xbb64b9a8, 0x361f3c00, 0xbb64b9a8, 0xbb648000, 0x361fb9a8, 0xbb648000, 0x361fb9a8
.long 0x34a53c00, 0xba2fbaa7, 0xbba80000, 0x3913b872, 0xbba88000, 0x3913b872, 0xb4a5bc00, 0x3a2f3aa7
.long 0x323e3c00, 0xb872bb64, 0xb23ebc00, 0x38723b64, 0xbbd98000, 0x3aa7b61f, 0x3bd98000, 0xbaa7361f
.long 0x2e463c00, 0xb4a5bbd9, 0x3bf68000, 0xbba8323e, 0xbbf68000, 0x3ba8b23e, 0x2e463c00, 0xb4a5bbd9
.long 0xb9a8bc00, 0x39a88000, 0xb9a8bc00, 0x39a88000, 0x39a88000, 0x39a83c00, 0x39a88000, 0x39a83c00
.long 0xb4a5bb64, 0x3bf63872, 0x3ba8361f, 0x2e463aa7, 0x3ba8361f, 0x2e463aa7, 0x34a53b64, 0xbbf6b872
.long 0x323eb9a8, 0x3aa73b64, 0xb23e39a8, 0xbaa7bb64, 0x3bd939a8, 0xb872361f, 0xbbd9b9a8, 0x3872b61f
.long 0x3913b61f, 0x34a53bd9, 0xba2fbb64, 0x3ba8323e, 0x3a2f3b64, 0xbba8b23e, 0x3913b61f, 0x34a53bd9
.long 0x3b648000, 0xb61f39a8, 0x3b648000, 0xb61f39a8, 0x361f3c00, 0xbb64b9a8, 0x361f3c00, 0xbb64b9a8
.long 0x3bf6361f, 0xbb0e323e, 0xae463b64, 0xb78bbbd9, 0xae463b64, 0xb78bbbd9, 0xbbf6b61f, 0x3b0eb23e
.long 0x3aa739a8, 0xbbd9b61f, 0xbaa7b9a8, 0x3bd9361f, 0xb87239a8, 0x323ebb64, 0x3872b9a8, 0xb23e3b64
.long 0x378b3b64, 0xb913baa7, 0x3b0eb61f, 0xba2f3872, 0xbb0e361f, 0x3a2fb872, 0x378b3b64, 0xb913baa7
.long 0x39a83c00, 0xb9a80000, 0x39a83c00, 0xb9a80000, 0xb9a88000, 0xb9a8bc00, 0xb9a88000, 0xb9a8bc00
.long 0xae4639a8, 0xbba8baa7, 0xbbf6b9a8, 0x34a5b872, 0xbbf6b9a8, 0x34a5b872, 0x2e46b9a8, 0x3ba83aa7
.long 0xbaa70000, 0xb23ebb64, 0x3aa78000, 0x323e3b64, 0xb872bc00, 0x3bd9361f, 0x38723c00, 0xbbd9b61f
.long 0xbba8b9a8, 0x3a2fb23e, 0xb4a539a8, 0xb913bbd9, 0x34a5b9a8, 0x39133bd9, 0xbba8b9a8, 0x3a2fb23e
.long 0xb61fbc00, 0x3b6439a8, 0xb61fbc00, 0x3b6439a8, 0x3b648000, 0xb61f39a8, 0x3b648000, 0xb61f39a8
.long 0x378bb9a8, 0x2e463bd9, 0x3b0e39a8, 0xbbf6b23e, 0x3b0e39a8, 0xbbf6b23e, 0xb78b39a8, 0xae46bbd9
.long 0x3bd98000, 0xbaa7361f, 0xbbd90000, 0x3aa7b61f, 0x323e3c00, 0xb872bb64, 0xb23ebc00, 0x38723b64
.long 0x3a2f39a8, 0xbb0eb872, 0x3913b9a8, 0xb78b3aa7, 0xb91339a8, 0x378bbaa7, 0x3a2f39a8, 0xbb0eb872
.long 0xb9a8bc00, 0x39a88000, 0xb9a8bc00, 0x39a88000, 0x39a88000, 0x39a83c00, 0x39a88000, 0x39a83c00
.long 0x378bb61f, 0x3a2f3bd9, 0x3b0e3b64, 0xb913323e, 0x3b0e3b64, 0xb913323e, 0xb78b361f, 0xba2fbbd9
.long 0x3bd939a8, 0xb872361f, 0xbbd9b9a8, 0x3872b61f, 0xb23e39a8, 0xbaa7bb64, 0x323eb9a8, 0x3aa73b64
.long 0x2e463b64, 0xbb0ebaa7, 0x3bf6361f, 0xb78b3872, 0xbbf6b61f, 0x378bb872, 0x2e463b64, 0xbb0ebaa7
.long 0xbb640000, 0x361fb9a8, 0xbb640000, 0x361fb9a8, 0xb61fbc00, 0x3b6439a8, 0xb61fbc00, 0x3b6439a8
.long 0xb913bb64, 0x3ba83872, 0x3a2fb61f, 0xb4a53aa7, 0x3a2fb61f, 0xb4a53aa7, 0x39133b64, 0xbba8b872
.long 0x3872b9a8, 0xb23e3b64, 0xb87239a8, 0x323ebb64, 0x3aa739a8, 0xbbd9b61f, 0xbaa7b9a8, 0x3bd9361f
.long 0x3ba8361f, 0xbbf6b23e, 0x34a5bb64, 0xae463bd9, 0xb4a53b64, 0x2e46bbd9, 0x3ba8361f, 0xbbf6b23e
.long 0x39a83c00, 0xb9a80000, 0x39a83c00, 0xb9a80000, 0xb9a88000, 0xb9a8bc00, 0xb9a88000, 0xb9a8bc00
.long 0xb913bc00, 0x3b0e323e, 0x3a2f8000, 0x378b3bd9, 0x3a2f8000, 0x378b3bd9, 0x39133c00, 0xbb0eb23e
.long 0x38723c00, 0xbbd9b61f, 0xb872bc00, 0x3bd9361f, 0xbaa78000, 0xb23ebb64, 0x3aa78000, 0x323e3b64
.long 0xb78bbc00, 0x3bf63872, 0xbb0e0000, 0x2e46baa7, 0x3b0e8000, 0xae463aa7, 0xb78bbc00, 0x3bf63872
.long 0x361f3c00, 0xbb64b9a8, 0x361f3c00, 0xbb64b9a8, 0xbb648000, 0x361fb9a8, 0xbb648000, 0x361fb9a8
.long 0xb4a5bc00, 0x3a2f3aa7, 0x3ba88000, 0xb9133872, 0x3ba88000, 0xb9133872, 0x34a53c00, 0xba2fbaa7
.long 0x323e3c00, 0xb872bb64, 0xb23ebc00, 0x38723b64, 0xbbd98000, 0x3aa7b61f, 0x3bd98000, 0xbaa7361f
.long 0xae46bc00, 0x34a53bd9, 0xbbf60000, 0x3ba8b23e, 0x3bf68000, 0xbba8323e, 0xae46bc00, 0x34a53bd9
.long 0xb9a8bc00, 0x39a88000, 0xb9a8bc00, 0x39a88000, 0x39a88000, 0x39a83c00, 0x39a88000, 0x39a83c00
.long 0x34a53b64, 0xbbf6b872, 0xbba8b61f, 0xae46baa7, 0xbba8b61f, 0xae46baa7, 0xb4a5bb64, 0x3bf63872
.long 0x323eb9a8, 0x3aa73b64, 0xb23e39a8, 0xbaa7bb64, 0x3bd939a8, 0xb872361f, 0xbbd9b9a8, 0x3872b61f
.long 0xb913361f, 0xb4a5bbd9, 0x3a2f3b64, 0xbba8b23e, 0xba2fbb64, 0x3ba8323e, 0xb913361f, 0xb4a5bbd9
.long 0x3b648000, 0xb61f39a8, 0x3b648000, 0xb61f39a8, 0x361f3c00, 0xbb64b9a8, 0x361f3c00, 0xbb64b9a8
.long 0xbbf6b61f, 0x3b0eb23e, 0x2e46bb64, 0x378b3bd9, 0x2e46bb64, 0x378b3bd9, 0x3bf6361f, 0xbb0e323e
.long 0x3aa739a8, 0xbbd9b61f, 0xbaa7b9a8, 0x3bd9361f, 0xb87239a8, 0x323ebb64, 0x3872b9a8, 0xb23e3b64
.long 0xb78bbb64, 0x39133aa7, 0xbb0e361f, 0x3a2fb872, 0x3b0eb61f, 0xba2f3872, 0xb78bbb64, 0x39133aa7
.long 0x39a83c00, 0xb9a80000, 0x39a83c00, 0xb9a80000, 0xb9a88000, 0xb9a8bc00, 0xb9a88000, 0xb9a8bc00
.long 0x2e46b9a8, 0x3ba83aa7, 0x3bf639a8, 0xb4a53872, 0x3bf639a8, 0xb4a53872, 0xae4639a8, 0xbba8baa7
.long 0xbaa70000, 0xb23ebb64, 0x3aa78000, 0x323e3b64, 0xb872bc00, 0x3bd9361f, 0x38723c00, 0xbbd9b61f
.long 0x3ba839a8, 0xba2f323e, 0x34a5b9a8, 0x39133bd9, 0xb4a539a8, 0xb913bbd9, 0x3ba839a8, 0xba2f323e
.long 0xb61fbc00, 0x3b6439a8, 0xb61fbc00, 0x3b6439a8, 0x3b648000, 0xb61f39a8, 0x3b648000, 0xb61f39a8
.long 0xb78b39a8, 0xae46bbd9, 0xbb0eb9a8, 0x3bf6323e, 0xbb0eb9a8, 0x3bf6323e, 0x378bb9a8, 0x2e463bd9
.long 0x3bd98000, 0xbaa7361f, 0xbbd90000, 0x3aa7b61f, 0x323e3c00, 0xb872bb64, 0xb23ebc00, 0x38723b64
.long 0xba2fb9a8, 0x3b0e3872, 0xb91339a8, 0x378bbaa7, 0x3913b9a8, 0xb78b3aa7, 0xba2fb9a8, 0x3b0e3872
.long 0xb9a8bc00, 0x39a88000, 0xb9a8bc00, 0x39a88000, 0x39a88000, 0x39a83c00, 0x39a88000, 0x39a83c00
.long 0xb78b361f, 0xba2fbbd9, 0xbb0ebb64, 0x3913b23e, 0xbb0ebb64, 0x3913b23e, 0x378bb61f, 0x3a2f3bd9
.long 0x3bd939a8, 0xb872361f, 0xbbd9b9a8, 0x3872b61f, 0xb23e39a8, 0xbaa7bb64, 0x323eb9a8, 0x3aa73b64
.long 0xae46bb64, 0x3b0e3aa7, 0xbbf6b61f, 0x378bb872, 0x3bf6361f, 0xb78b3872, 0xae46bb64, 0x3b0e3aa7
.long 0xbb640000, 0x361fb9a8, 0xbb640000, 0x361fb9a8, 0xb61fbc00, 0x3b6439a8, 0xb61fbc00, 0x3b6439a8
.long 0x39133b64, 0xbba8b872, 0xba2f361f, 0x34a5baa7, 0xba2f361f, 0x34a5baa7, 0xb913bb64, 0x3ba83872
.long 0x3872b9a8, 0xb23e3b64, 0xb87239a8, 0x323ebb64, 0x3aa739a8, 0xbbd9b61f, 0xbaa7b9a8, 0x3bd9361f
.long 0xbba8b61f, 0x3bf6323e, 0xb4a53b64, 0x2e46bbd9, 0x34a5bb64, 0xae463bd9, 0xbba8b61f, 0x3bf6323e
.long 0x00003c00, 0x8000bc00, 0x00003c00, 0x8000bc00, 0xbc008000, 0x3c008000, 0xbc008000, 0x3c008000
.long 0xae463c00, 0x34a5bbd9, 0xbbf60000, 0x3ba8323e, 0xbbf68000, 0x3ba8323e, 0x2e46bc00, 0xb4a53bd9
.long 0xb23e3c00, 0x3872bb64, 0x323ebc00, 0xb8723b64, 0xbbd98000, 0x3aa7361f, 0x3bd98000, 0xbaa7b61f
.long 0xb4a53c00, 0x3a2fbaa7, 0x3ba88000, 0xb913b872, 0xbba88000, 0x39133872, 0xb4a53c00, 0x3a2fbaa7
.long 0xb61f3c00, 0x3b64b9a8, 0xb61f3c00, 0x3b64b9a8, 0xbb648000, 0x361f39a8, 0xbb648000, 0x361f39a8
.long 0xb78b3c00, 0x3bf6b872, 0xbb0e0000, 0x2e463aa7, 0xbb0e8000, 0x2e463aa7, 0x378bbc00, 0xbbf63872
.long 0xb8723c00, 0x3bd9b61f, 0x3872bc00, 0xbbd9361f, 0xbaa78000, 0xb23e3b64, 0x3aa78000, 0x323ebb64
.long 0xb9133c00, 0x3b0eb23e, 0x3a2f8000, 0x378bbbd9, 0xba2f8000, 0xb78b3bd9, 0xb9133c00, 0x3b0eb23e
.long 0x00003c00, 0x8000bc00, 0x00003c00, 0x8000bc00, 0xbc008000, 0x3c008000, 0xbc008000, 0x3c008000
.long 0xb78b3b64, 0x3913baa7, 0xbb0eb61f, 0x3a2f3872, 0xbb0eb61f, 0x3a2f3872, 0x378bbb64, 0xb9133aa7
.long 0xbaa739a8, 0x3bd9b61f, 0x3aa7b9a8, 0xbbd9361f, 0xb872b9a8, 0x323e3b64, 0x387239a8, 0xb23ebb64
.long 0xbbf6361f, 0x3b0e323e, 0x2e463b64, 0x378bbbd9, 0xae46bb64, 0xb78b3bd9, 0xbbf6361f, 0x3b0e323e
.long 0xbb640000, 0x361f39a8, 0xbb640000, 0x361f39a8, 0x361fbc00, 0xbb6439a8, 0x361fbc00, 0xbb6439a8
.long 0xb913b61f, 0xb4a53bd9, 0x3a2fbb64, 0xbba8323e, 0x3a2fbb64, 0xbba8323e, 0x3913361f, 0x34a5bbd9
.long 0xb23eb9a8, 0xbaa73b64, 0x323e39a8, 0x3aa7bb64, 0x3bd9b9a8, 0xb872b61f, 0xbbd939a8, 0x3872361f
.long 0x34a5bb64, 0xbbf63872, 0xbba8361f, 0xae463aa7, 0x3ba8b61f, 0x2e46baa7, 0x34a5bb64, 0xbbf63872
.long 0x00003c00, 0x8000bc00, 0x00003c00, 0x8000bc00, 0xbc008000, 0x3c008000, 0xbc008000, 0x3c008000
.long 0xba2f39a8, 0x3b0eb872, 0xb913b9a8, 0x378b3aa7, 0xb913b9a8, 0x378b3aa7, 0x3a2fb9a8, 0xbb0e3872
.long 0xbbd90000, 0x3aa7361f, 0x3bd98000, 0xbaa7b61f, 0x323ebc00, 0xb8723b64, 0xb23e3c00, 0x3872bb64
.long 0xb78bb9a8, 0xae463bd9, 0xbb0e39a8, 0x3bf6b23e, 0x3b0eb9a8, 0xbbf6323e, 0xb78bb9a8, 0xae463bd9
.long 0x361fbc00, 0xbb6439a8, 0x361fbc00, 0xbb6439a8, 0x3b648000, 0xb61fb9a8, 0x3b648000, 0xb61fb9a8
.long 0x3ba8b9a8, 0xba2fb23e, 0x34a539a8, 0x3913bbd9, 0x34a539a8, 0x3913bbd9, 0xbba839a8, 0x3a2f323e
.long 0x3aa78000, 0x323ebb64, 0xbaa70000, 0xb23e3b64, 0xb8723c00, 0x3bd9b61f, 0x3872bc00, 0xbbd9361f
.long 0x2e4639a8, 0x3ba8baa7, 0x3bf6b9a8, 0xb4a5b872, 0xbbf639a8, 0x34a53872, 0x2e4639a8, 0x3ba8baa7
.long 0x00003c00, 0x8000bc00, 0x00003c00, 0x8000bc00, 0xbc008000, 0x3c008000, 0xbc008000, 0x3c008000
.long 0xbba8361f, 0x3bf6b23e, 0xb4a5bb64, 0x2e463bd9, 0xb4a5bb64, 0x2e463bd9, 0x3ba8b61f, 0xbbf6323e
.long 0xb872b9a8, 0x323e3b64, 0x387239a8, 0xb23ebb64, 0x3aa7b9a8, 0xbbd9361f, 0xbaa739a8, 0x3bd9b61f
.long 0x3913bb64, 0xbba83872, 0xba2fb61f, 0x34a53aa7, 0x3a2f361f, 0xb4a5baa7, 0x3913bb64, 0xbba83872
.long 0x3b648000, 0xb61fb9a8, 0x3b648000, 0xb61fb9a8, 0xb61f3c00, 0x3b64b9a8, 0xb61f3c00, 0x3b64b9a8
.long 0xae463b64, 0x3b0ebaa7, 0xbbf6361f, 0x378b3872, 0xbbf6361f, 0x378b3872, 0x2e46bb64, 0xbb0e3aa7
.long 0xbbd939a8, 0x3872361f, 0x3bd9b9a8, 0xb872b61f, 0xb23eb9a8, 0xbaa73b64, 0x323e39a8, 0x3aa7bb64
.long 0xb78bb61f, 0xba2f3bd9, 0xbb0e3b64, 0x3913323e, 0x3b0ebb64, 0xb913b23e, 0xb78bb61f, 0xba2f3bd9
.long 0x00003c00, 0x8000bc00, 0x00003c00, 0x8000bc00, 0xbc008000, 0x3c008000, 0xbc008000, 0x3c008000
.long 0x2e46bc00, 0xb4a53bd9, 0x3bf68000, 0xbba8b23e, 0x3bf68000, 0xbba8b23e, 0xae463c00, 0x34a5bbd9
.long 0xb23e3c00, 0x3872bb64, 0x323ebc00, 0xb8723b64, 0xbbd98000, 0x3aa7361f, 0x3bd98000, 0xbaa7b61f
.long 0x34a5bc00, 0xba2f3aa7, 0xbba80000, 0x39133872, 0x3ba88000, 0xb913b872, 0x34a5bc00, 0xba2f3aa7
.long 0xb61f3c00, 0x3b64b9a8, 0xb61f3c00, 0x3b64b9a8, 0xbb648000, 0x361f39a8, 0xbb648000, 0x361f39a8
.long 0x378bbc00, 0xbbf63872, 0x3b0e8000, 0xae46baa7, 0x3b0e8000, 0xae46baa7, 0xb78b3c00, 0x3bf6b872
.long 0xb8723c00, 0x3bd9b61f, 0x3872bc00, 0xbbd9361f, 0xbaa78000, 0xb23e3b64, 0x3aa78000, 0x323ebb64
.long 0x3913bc00, 0xbb0e323e, 0xba2f0000, 0xb78b3bd9, 0x3a2f8000, 0x378bbbd9, 0x3913bc00, 0xbb0e323e
.long 0x00003c00, 0x8000bc00, 0x00003c00, 0x8000bc00, 0xbc008000, 0x3c008000, 0xbc008000, 0x3c008000
.long 0x378bbb64, 0xb9133aa7, 0x3b0e361f, 0xba2fb872, 0x3b0e361f, 0xba2fb872, 0xb78b3b64, 0x3913baa7
.long 0xbaa739a8, 0x3bd9b61f, 0x3aa7b9a8, 0xbbd9361f, 0xb872b9a8, 0x323e3b64, 0x387239a8, 0xb23ebb64
.long 0x3bf6b61f, 0xbb0eb23e, 0xae46bb64, 0xb78b3bd9, 0x2e463b64, 0x378bbbd9, 0x3bf6b61f, 0xbb0eb23e
.long 0xbb640000, 0x361f39a8, 0xbb640000, 0x361f39a8, 0x361fbc00, 0xbb6439a8, 0x361fbc00, 0xbb6439a8
.long 0x3913361f, 0x34a5bbd9, 0xba2f3b64, 0x3ba8b23e, 0xba2f3b64, 0x3ba8b23e, 0xb913b61f, 0xb4a53bd9
.long 0xb23eb9a8, 0xbaa73b64, 0x323e39a8, 0x3aa7bb64, 0x3bd9b9a8, 0xb872b61f, 0xbbd939a8, 0x3872361f
.long 0xb4a53b64, 0x3bf6b872, 0x3ba8b61f, 0x2e46baa7, 0xbba8361f, 0xae463aa7, 0xb4a53b64, 0x3bf6b872
.long 0x00003c00, 0x8000bc00, 0x00003c00, 0x8000bc00, 0xbc008000, 0x3c008000, 0xbc008000, 0x3c008000
.long 0x3a2fb9a8, 0xbb0e3872, 0x391339a8, 0xb78bbaa7, 0x391339a8, 0xb78bbaa7, 0xba2f39a8, 0x3b0eb872
.long 0xbbd90000, 0x3aa7361f, 0x3bd98000, 0xbaa7b61f, 0x323ebc00, 0xb8723b64, 0xb23e3c00, 0x3872bb64
.long 0x378b39a8, 0x2e46bbd9, 0x3b0eb9a8, 0xbbf6323e, 0xbb0e39a8, 0x3bf6b23e, 0x378b39a8, 0x2e46bbd9
.long 0x361fbc00, 0xbb6439a8, 0x361fbc00, 0xbb6439a8, 0x3b648000, 0xb61fb9a8, 0x3b648000, 0xb61fb9a8
.long 0xbba839a8, 0x3a2f323e, 0xb4a5b9a8, 0xb9133bd9, 0xb4a5b9a8, 0xb9133bd9, 0x3ba8b9a8, 0xba2fb23e
.long 0x3aa78000, 0x323ebb64, 0xbaa70000, 0xb23e3b64, 0xb8723c00, 0x3bd9b61f, 0x3872bc00, 0xbbd9361f
.long 0xae46b9a8, 0xbba83aa7, 0xbbf639a8, 0x34a53872, 0x3bf6b9a8, 0xb4a5b872, 0xae46b9a8, 0xbba83aa7
.long 0x00003c00, 0x8000bc00, 0x00003c00, 0x8000bc00, 0xbc008000, 0x3c008000, 0xbc008000, 0x3c008000
.long 0x3ba8b61f, 0xbbf6323e, 0x34a53b64, 0xae46bbd9, 0x34a53b64, 0xae46bbd9, 0xbba8361f, 0x3bf6b23e
.long 0xb872b9a8, 0x323e3b64, 0x387239a8, 0xb23ebb64, 0x3aa7b9a8, 0xbbd9361f, 0xbaa739a8, 0x3bd9b61f
.long 0xb9133b64, 0x3ba8b872, 0x3a2f361f, 0xb4a5baa7, 0xba2fb61f, 0x34a53aa7, 0xb9133b64, 0x3ba8b872
.long 0x3b648000, 0xb61fb9a8, 0x3b648000, 0xb61fb9a8, 0xb61f3c00, 0x3b64b9a8, 0xb61f3c00, 0x3b64b9a8
.long 0x2e46bb64, 0xbb0e3aa7, 0x3bf6b61f, 0xb78bb872, 0x3bf6b61f, 0xb78bb872, 0xae463b64, 0x3b0ebaa7
.long 0xbbd939a8, 0x3872361f, 0x3bd9b9a8, 0xb872b61f, 0xb23eb9a8, 0xbaa73b64, 0x323e39a8, 0x3aa7bb64
.long 0x378b361f, 0x3a2fbbd9, 0x3b0ebb64, 0xb913b23e, 0xbb0e3b64, 0x3913323e, 0x378b361f, 0x3a2fbbd9
.long 0xb9a83c00, 0x39a88000, 0xb9a83c00, 0x39a88000, 0xb9a88000, 0xb9a83c00, 0xb9a88000, 0xb9a83c00
.long 0xba2f3c00, 0x378b323e, 0xb9130000, 0xbb0e3bd9, 0xb9138000, 0xbb0e3bd9, 0x3a2fbc00, 0xb78bb23e
.long 0xbaa73c00, 0x323e361f, 0x3aa7bc00, 0xb23eb61f, 0xb8728000, 0xbbd93b64, 0x38728000, 0x3bd9bb64
.long 0xbb0e3c00, 0xae463872, 0x378b8000, 0x3bf6baa7, 0xb78b8000, 0xbbf63aa7, 0xbb0e3c00, 0xae463872
.long 0xbb643c00, 0xb61f39a8, 0xbb643c00, 0xb61f39a8, 0xb61f8000, 0xbb6439a8, 0xb61f8000, 0xbb6439a8
.long 0xbba83c00, 0xb9133aa7, 0xb4a50000, 0xba2f3872, 0xb4a58000, 0xba2f3872, 0x3ba8bc00, 0x3913baa7
.long 0xbbd93c00, 0xbaa73b64, 0x3bd9bc00, 0x3aa7bb64, 0xb23e8000, 0xb872361f, 0x323e8000, 0x3872b61f
.long 0xbbf63c00, 0xbba83bd9, 0x2e468000, 0x34a5b23e, 0xae468000, 0xb4a5323e, 0xbbf63c00, 0xbba83bd9
.long 0x39a8bc00, 0xb9a80000, 0x39a8bc00, 0xb9a80000, 0x39a88000, 0x39a8bc00, 0x39a88000, 0x39a8bc00
.long 0x3ba8bb64, 0xae46b872, 0x34a5361f, 0x3bf6baa7, 0x34a5361f, 0x3bf6baa7, 0xbba83b64, 0x2e463872
.long 0x3bd9b9a8, 0x3872bb64, 0xbbd939a8, 0xb8723b64, 0xb23e39a8, 0x3aa7b61f, 0x323eb9a8, 0xbaa7361f
.long 0x3a2fb61f, 0x3ba8bbd9, 0x3913bb64, 0xb4a5b23e, 0xb9133b64, 0x34a5323e, 0x3a2fb61f, 0x3ba8bbd9
.long 0x361f8000, 0x3b64b9a8, 0x361f8000, 0x3b64b9a8, 0xbb643c00, 0xb61f39a8, 0xbb643c00, 0xb61f39a8
.long 0xae46361f, 0x378bb23e, 0xbbf63b64, 0xbb0e3bd9, 0xbbf63b64, 0xbb0e3bd9, 0x2e46b61f, 0xb78b323e
.long 0xb87239a8, 0xb23e361f, 0x3872b9a8, 0x323eb61f, 0xbaa739a8, 0xbbd93b64, 0x3aa7b9a8, 0x3bd9bb64
.long 0xbb0e3b64, 0xba2f3aa7, 0x378bb61f, 0x3913b872, 0xb78b361f, 0xb9133872, 0xbb0e3b64, 0xba2f3aa7
.long 0xb9a83c00, 0x39a88000, 0xb9a83c00, 0x39a88000, 0xb9a88000, 0xb9a83c00, 0xb9a88000, 0xb9a83c00
.long 0xbbf639a8, 0xb4a53aa7, 0x2e46b9a8, 0xbba83872, 0x2e46b9a8, 0xbba83872, 0x3bf6b9a8, 0x34a5baa7
.long 0xb8720000, 0xbbd93b64, 0x38728000, 0x3bd9bb64, 0x3aa7bc00, 0xb23eb61f, 0xbaa73c00, 0x323e361f
.long 0x34a5b9a8, 0xb913323e, 0xbba839a8, 0xba2f3bd9, 0x3ba8b9a8, 0x3a2fbbd9, 0x34a5b9a8, 0xb913323e
.long 0x3b64bc00, 0x361fb9a8, 0x3b64bc00, 0x361fb9a8, 0x361f8000, 0x3b64b9a8, 0x361f8000, 0x3b64b9a8
.long 0x3b0eb9a8, 0x3bf6bbd9, 0xb78b39a8, 0x2e46323e, 0xb78b39a8, 0x2e46323e, 0xbb0e39a8, 0xbbf63bd9
.long 0x323e8000, 0x3872b61f, 0xb23e0000, 0xb872361f, 0xbbd93c00, 0xbaa73b64, 0x3bd9bc00, 0x3aa7bb64
.long 0xb91339a8, 0xb78b3872, 0x3a2fb9a8, 0x3b0ebaa7, 0xba2f39a8, 0xbb0e3aa7, 0xb91339a8, 0xb78b3872
.long 0x39a8bc00, 0xb9a80000, 0x39a8bc00, 0xb9a80000, 0x39a88000, 0x39a8bc00, 0x39a88000, 0x39a8bc00
.long 0x3b0eb61f, 0x3913bbd9, 0xb78b3b64, 0x3a2fb23e, 0xb78b3b64, 0x3a2fb23e, 0xbb0e361f, 0xb9133bd9
.long 0xb23e39a8, 0x3aa7b61f, 0x323eb9a8, 0xbaa7361f, 0xbbd939a8, 0xb8723b64, 0x3bd9b9a8, 0x3872bb64
.long 0xbbf63b64, 0xb78b3aa7, 0x2e46361f, 0x3b0eb872, 0xae46b61f, 0xbb0e3872, 0xbbf63b64, 0xb78b3aa7
.long 0xb61f0000, 0xbb6439a8, 0xb61f0000, 0xbb6439a8, 0x3b64bc00, 0x361fb9a8, 0x3b64bc00, 0x361fb9a8
.long 0x3a2fbb64, 0x34a5b872, 0x3913b61f, 0x3ba8baa7, 0x3913b61f, 0x3ba8baa7, 0xba2f3b64, 0xb4a53872
.long 0x3aa7b9a8, 0x3bd9bb64, 0xbaa739a8, 0xbbd93b64, 0xb87239a8, 0xb23e361f, 0x3872b9a8, 0x323eb61f
.long 0xb4a5361f, 0xae46323e, 0x3ba8bb64, 0x3bf6bbd9, 0xbba83b64, 0xbbf63bd9, 0xb4a5361f, 0xae46323e
.long 0xb9a83c00, 0x39a88000, 0xb9a83c00, 0x39a88000, 0xb9a88000, 0xb9a83c00, 0xb9a88000, 0xb9a83c00
.long 0x3a2fbc00, 0xb78bb23e, 0x39138000, 0x3b0ebbd9, 0x39138000, 0x3b0ebbd9, 0xba2f3c00, 0x378b323e
.long 0xbaa73c00, 0x323e361f, 0x3aa7bc00, 0xb23eb61f, 0xb8728000, 0xbbd93b64, 0x38728000, 0x3bd9bb64
.long 0x3b0ebc00, 0x2e46b872, 0xb78b0000, 0xbbf63aa7, 0x378b8000, 0x3bf6baa7, 0x3b0ebc00, 0x2e46b872
.long 0xbb643c00, 0xb61f39a8, 0xbb643c00, 0xb61f39a8, 0xb61f8000, 0xbb6439a8, 0xb61f8000, 0xbb6439a8
.long 0x3ba8bc00, 0x3913baa7, 0x34a58000, 0x3a2fb872, 0x34a58000, 0x3a2fb872, 0xbba83c00, 0xb9133aa7
.long 0xbbd93c00, 0xbaa73b64, 0x3bd9bc00, 0x3aa7bb64, 0xb23e8000, 0xb872361f, 0x323e8000, 0x3872b61f
.long 0x3bf6bc00, 0x3ba8bbd9, 0xae460000, 0xb4a5323e, 0x2e468000, 0x34a5b23e, 0x3bf6bc00, 0x3ba8bbd9
.long 0x39a8bc00, 0xb9a80000, 0x39a8bc00, 0xb9a80000, 0x39a88000, 0x39a8bc00, 0x39a88000, 0x39a8bc00
.long 0xbba83b64, 0x2e463872, 0xb4a5b61f, 0xbbf63aa7, 0xb4a5b61f, 0xbbf63aa7, 0x3ba8bb64, 0xae46b872
.long 0x3bd9b9a8, 0x3872bb64, 0xbbd939a8, 0xb8723b64, 0xb23e39a8, 0x3aa7b61f, 0x323eb9a8, 0xbaa7361f
.long 0xba2f361f, 0xbba83bd9, 0xb9133b64, 0x34a5323e, 0x3913bb64, 0xb4a5b23e, 0xba2f361f, 0xbba83bd9
.long 0x361f8000, 0x3b64b9a8, 0x361f8000, 0x3b64b9a8, 0xbb643c00, 0xb61f39a8, 0xbb643c00, 0xb61f39a8
.long 0x2e46b61f, 0xb78b323e, 0x3bf6bb64, 0x3b0ebbd9, 0x3bf6bb64, 0x3b0ebbd9, 0xae46361f, 0x378bb23e
.long 0xb87239a8, 0xb23e361f, 0x3872b9a8, 0x323eb61f, 0xbaa739a8, 0xbbd93b64, 0x3aa7b9a8, 0x3bd9bb64
.long 0x3b0ebb64, 0x3a2fbaa7, 0xb78b361f, 0xb9133872, 0x378bb61f, 0x3913b872, 0x3b0ebb64, 0x3a2fbaa7
.long 0xb9a83c00, 0x39a88000, 0xb9a83c00, 0x39a88000, 0xb9a88000, 0xb9a83c00, 0xb9a88000, 0xb9a83c00
.long 0x3bf6b9a8, 0x34a5baa7, 0xae4639a8, 0x3ba8b872, 0xae4639a8, 0x3ba8b872, 0xbbf639a8, 0xb4a53aa7
.long 0xb8720000, 0xbbd93b64, 0x38728000, 0x3bd9bb64, 0x3aa7bc00, 0xb23eb61f, 0xbaa73c00, 0x323e361f
.long 0xb4a539a8, 0x3913b23e, 0x3ba8b9a8, 0x3a2fbbd9, 0xbba839a8, 0xba2f3bd9, 0xb4a539a8, 0x3913b23e
.long 0x3b64bc00, 0x361fb9a8, 0x3b64bc00, 0x361fb9a8, 0x361f8000, 0x3b64b9a8, 0x361f8000, 0x3b64b9a8
.long 0xbb0e39a8, 0xbbf63bd9, 0x378bb9a8, 0xae46b23e, 0x378bb9a8, 0xae46b23e, 0x3b0eb9a8, 0x3bf6bbd9
.long 0x323e8000, 0x3872b61f, 0xb23e0000, 0xb872361f, 0xbbd93c00, 0xbaa73b64, 0x3bd9bc00, 0x3aa7bb64
.long 0x3913b9a8, 0x378bb872, 0xba2f39a8, 0xbb0e3aa7, 0x3a2fb9a8, 0x3b0ebaa7, 0x3913b9a8, 0x378bb872
.long 0x39a8bc00, 0xb9a80000, 0x39a8bc00, 0xb9a80000, 0x39a88000, 0x39a8bc00, 0x39a88000, 0x39a8bc00
.long 0xbb0e361f, 0xb9133bd9, 0x378bbb64, 0xba2f323e, 0x378bbb64, 0xba2f323e, 0x3b0eb61f, 0x3913bbd9
.long 0xb23e39a8, 0x3aa7b61f, 0x323eb9a8, 0xbaa7361f, 0xbbd939a8, 0xb8723b64, 0x3bd9b9a8, 0x3872bb64
.long 0x3bf6bb64, 0x378bbaa7, 0xae46b61f, 0xbb0e3872, 0x2e46361f, 0x3b0eb872, 0x3bf6bb64, 0x378bbaa7
.long 0xb61f0000, 0xbb6439a8, 0xb61f0000, 0xbb6439a8, 0x3b64bc00, 0x361fb9a8, 0x3b64bc00, 0x361fb9a8
.long 0xba2f3b64, 0xb4a53872, 0xb913361f, 0xbba83aa7, 0xb913361f, 0xbba83aa7, 0x3a2fbb64, 0x34a5b872
.long 0x3aa7b9a8, 0x3bd9bb64, 0xbaa739a8, 0xbbd93b64, 0xb87239a8, 0xb23e361f, 0x3872b9a8, 0x323eb61f
.long 0x34a5b61f, 0x2e46b23e, 0xbba83b64, 0xbbf63bd9, 0x3ba8bb64, 0x3bf6bbd9, 0x34a5b61f, 0x2e46b23e
.globl kb_kernel
.p2align 8
.type kb_kernel,@function
kb_kernel:

    s_cmp_ge_u32 s2, 256
    s_cbranch_scc1 L_kb_end
    v_lshrrev_b32 v1, 6, v0
    s_load_dwordx2 s[4:5], s[0:1], 0
    s_load_dwordx2 s[10:11], s[0:1], 88
    v_readfirstlane_b32 s6, v1
    v_and_b32 v2, 63, v0
    s_getpc_b64 s[20:21]
L_kb_pc:
    s_add_u32 s20, s20, T_kb-L_kb_pc
    s_addc_u32 s21, s21, 0
    s_mov_b32 s22, 15360
    s_mov_b32 s23, 0x00020000
    s_cmp_eq_u32 s6, 4
    s_cselect_b32 s3, s2, 0
    s_cmp_lg_u32 s3, 0
    s_cbranch_scc1 L_kb_end
    v_lshrrev_b32 v3, 4, v2
    v_and_b32 v4, 15, v2
    v_lshlrev_b32 v6, 4, v2
    s_and_b32 s7, s2, 7
    s_lshr_b32 s8, s2, 3
    s_lshr_b32 s9, s8, 3
    s_lshl_b32 s9, s9, 3
    s_add_u32 s7, s7, s9
    s_and_b32 s8, s8, 7
    s_lshl_b32 s24, s7, 6
    s_lshl_b32 s25, s6, 4
    s_add_u32 s24, s24, s25
    s_mul_i32 s24, s24, 1280
    s_mul_i32 s25, s6, 20480
    v_lshlrev_b32 v20, 1, v3
    v_xor_b32 v20, v20, v4
    v_xor_b32 v21, 8, v20
    v_mul_u32_u24 v19, 1280, v3
    v_lshl_add_u32 v20, v20, 4, v19
    v_lshl_add_u32 v21, v21, 4, v19
    s_waitcnt lgkmcnt(0)
    s_mov_b32 s12, s10
    s_mov_b32 s13, s11
    s_mov_b32 s14, 2621440
    s_mov_b32 s15, 0x00020000
    s_mov_b32 s16, s4
    s_mov_b32 s17, s5
    s_mov_b32 s18, 2621440
    s_mov_b32 s19, 0x00020000
    s_cmp_eq_u32 s6, 4
    s_cbranch_scc1 L_kb_noload
    s_add_u32 m0, s25, 0
    s_add_u32 s26, s24, 0
    buffer_load_dwordx4 v20, s[12:15], s26 offen lds
    s_add_u32 m0, s25, 1024
    s_add_u32 s26, s24, 256
    buffer_load_dwordx4 v20, s[12:15], s26 offen lds
    s_add_u32 m0, s25, 2048
    s_add_u32 s26, s24, 512
    buffer_load_dwordx4 v20, s[12:15], s26 offen lds
    s_add_u32 m0, s25, 3072
    s_add_u32 s26, s24, 768
    buffer_load_dwordx4 v20, s[12:15], s26 offen lds
    s_add_u32 m0, s25, 4096
    s_add_u32 s26, s24, 1024
    buffer_load_dwordx4 v20, s[12:15], s26 offen lds
    s_add_u32 m0, s25, 5120
    s_add_u32 s26, s24, 5120
    buffer_load_dwordx4 v21, s[12:15], s26 offen lds
    s_add_u32 m0, s25, 6144
    s_add_u32 s26, s24, 5376
    buffer_load_dwordx4 v21, s[12:15], s26 offen lds
    s_add_u32 m0, s25, 7168
    s_add_u32 s26, s24, 5632
    buffer_load_dwordx4 v21, s[12:15], s26 offen lds
    s_add_u32 m0, s25, 8192
    s_add_u32 s26, s24, 5888
    buffer_load_dwordx4 v21, s[12:15], s26 offen lds
    s_add_u32 m0, s25, 9216
    s_add_u32 s26, s24, 6144
    buffer_load_dwordx4 v21, s[12:15], s26 offen lds
    s_add_u32 m0, s25, 10240
    s_add_u32 s26, s24, 10240
    buffer_load_dwordx4 v20, s[12:15], s26 offen lds
    s_add_u32 m0, s25, 11264
    s_add_u32 s26, s24, 10496
    buffer_load_dwordx4 v20, s[12:15], s26 offen lds
    s_add_u32 m0, s25, 12288
    s_add_u32 s26, s24, 10752
    buffer_load_dwordx4 v20, s[12:15], s26 offen lds
    s_add_u32 m0, s25, 13312
    s_add_u32 s26, s24, 11008
    buffer_load_dwordx4 v20, s[12:15], s26 offen lds
    s_add_u32 m0, s25, 14336
    s_add_u32 s26, s24, 11264
    buffer_load_dwordx4 v20, s[12:15], s26 offen lds
    s_add_u32 m0, s25, 15360
    s_add_u32 s26, s24, 15360
    buffer_load_dwordx4 v21, s[12:15], s26 offen lds
    s_add_u32 m0, s25, 16384
    s_add_u32 s26, s24, 15616
    buffer_load_dwordx4 v21, s[12:15], s26 offen lds
    s_add_u32 m0, s25, 17408
    s_add_u32 s26, s24, 15872
    buffer_load_dwordx4 v21, s[12:15], s26 offen lds
    s_add_u32 m0, s25, 18432
    s_add_u32 s26, s24, 16128
    buffer_load_dwordx4 v21, s[12:15], s26 offen lds
    s_add_u32 m0, s25, 19456
    s_add_u32 s26, s24, 16384
    buffer_load_dwordx4 v21, s[12:15], s26 offen lds
    s_lshl_b32 s26, s6, 12
    s_add_u32 s27, s26, 0
    s_min_u32 s27, s27, 14336
    s_add_u32 m0, s27, 81920
    s_nop 0
    buffer_load_dwordx4 v6, s[20:23], s27 offen lds
    s_add_u32 s27, s26, 1024
    s_min_u32 s27, s27, 14336
    s_add_u32 m0, s27, 81920
    s_nop 0
    buffer_load_dwordx4 v6, s[20:23], s27 offen lds
    s_add_u32 s27, s26, 2048
    s_min_u32 s27, s27, 14336
    s_add_u32 m0, s27, 81920
    s_nop 0
    buffer_load_dwordx4 v6, s[20:23], s27 offen lds
    s_add_u32 s27, s26, 3072
    s_min_u32 s27, s27, 14336
    s_add_u32 m0, s27, 81920
    s_nop 0
    buffer_load_dwordx4 v6, s[20:23], s27 offen lds
L_kb_noload:
    s_lshl_b32 s9, s8, 8
    s_add_u32 s9, s9, s7
    s_and_b32 s26, s8, 3
    s_lshl_b32 s26, s26, 8
    s_lshr_b32 s27, s8, 2
    s_lshl_b32 s28, s27, 5
    s_add_u32 s26, s26, s28
    s_cmp_eq_u32 s7, 0
    s_cselect_b32 s9, s26, s9
    s_mov_b32 s29, 0x3c800000
    s_mov_b32 s30, 0x3c800000
    s_mov_b32 s31, 0xbe800000
    s_cbranch_scc0 L_kb_gen
    s_mov_b32 s31, 0
    s_cmp_eq_u32 s27, 1
    s_cselect_b32 s29, 0, s29
    s_cselect_b32 s30, s30, 0
L_kb_gen:
    s_add_u32 s32, s10, 2621440
    s_addc_u32 s33, s11, 0
    s_mov_b32 s34, 2621440
    s_mov_b32 s35, 0x00020000
    s_add_u32 s36, s10, 5242880
    s_addc_u32 s37, s11, 0
    s_mov_b32 s38, 2621440
    s_mov_b32 s39, 0x00020000
    s_lshl_b32 s26, s6, 6
    s_add_u32 s40, s9, s26
    s_cmp_eq_u32 s6, 4
    s_cselect_b32 s40, 1024, s40
    s_sub_u32 s41, 2048, s40
    s_and_b32 s41, s41, 2047
    v_mov_b32 v7, s40
    v_mov_b32 v8, s41
    v_cmp_gt_u32 vcc, 32, v2
    s_nop 1
    v_cndmask_b32 v7, v8, v7, vcc
    v_and_b32 v8, 31, v2
    v_mul_u32_u24 v9, 1280, v7
    v_lshl_add_u32 v9, v8, 4, v9
    v_cmp_gt_u32 s[42:43], 16, v8
    v_add_u32 v10, 1024, v9
    s_nop 0
    v_cndmask_b32 v10, v9, v10, s[42:43]
    buffer_load_dwordx4 v[152:155], v9, s[16:19], 0 offen
    buffer_load_dwordx4 v[156:159], v9, s[16:19], 0 offen offset:512
    buffer_load_dwordx4 v[160:163], v10, s[16:19], 0 offen
    v_lshrrev_b32 v11, 5, v7
    v_mul_u32_u24 v11, 40960, v11
    v_and_b32 v12, 31, v7
    v_lshl_add_u32 v11, v12, 4, v11
    v_lshl_add_u32 v11, v8, 9, v11
    v_lshrrev_b32 v13, 1, v4
    v_cmp_eq_u32 vcc, 4, v13
    v_lshlrev_b32 v13, 6, v13
    v_add_u32 v13, s9, v13
    v_mov_b32 v14, 0x400
    v_cndmask_b32 v13, v13, v14, vcc
    v_and_b32 v14, 1, v4
    v_cvt_f32_u32 v14, v14
    v_mul_f32 v14, 0.25, v14
    v_add_f32 v15, s31, v14
    v_cmp_gt_u32 vcc, 10, v4
    v_mov_b32 v16, s29
    v_mov_b32 v17, s30
    v_cndmask_b32 v16, 0, v16, vcc
    v_cndmask_b32 v17, 0, v17, vcc
    v_lshlrev_b32 v18, 2, v3
    s_mov_b32 s44, 0x3a000000
    v_add_u32 v24, 0, v18
    v_add_u32 v25, 1, v18
    v_add_u32 v26, 2, v18
    v_add_u32 v27, 3, v18
    v_add_u32 v28, 16, v18
    v_add_u32 v29, 17, v18
    v_add_u32 v30, 18, v18
    v_add_u32 v31, 19, v18
    v_mul_u32_u24 v24, v24, v13
    v_mul_u32_u24 v25, v25, v13
    v_mul_u32_u24 v26, v26, v13
    v_mul_u32_u24 v27, v27, v13
    v_mul_u32_u24 v28, v28, v13
    v_mul_u32_u24 v29, v29, v13
    v_mul_u32_u24 v30, v30, v13
    v_mul_u32_u24 v31, v31, v13
    v_and_b32 v24, 0x7ff, v24
    v_and_b32 v25, 0x7ff, v25
    v_and_b32 v26, 0x7ff, v26
    v_and_b32 v27, 0x7ff, v27
    v_and_b32 v28, 0x7ff, v28
    v_and_b32 v29, 0x7ff, v29
    v_and_b32 v30, 0x7ff, v30
    v_and_b32 v31, 0x7ff, v31
    v_cvt_f32_u32 v24, v24
    v_cvt_f32_u32 v25, v25
    v_cvt_f32_u32 v26, v26
    v_cvt_f32_u32 v27, v27
    v_cvt_f32_u32 v28, v28
    v_cvt_f32_u32 v29, v29
    v_cvt_f32_u32 v30, v30
    v_cvt_f32_u32 v31, v31
    v_fma_f32 v32, v24, s44, v14
    v_fma_f32 v40, v24, s44, v15
    v_fma_f32 v33, v25, s44, v14
    v_fma_f32 v41, v25, s44, v15
    v_fma_f32 v34, v26, s44, v14
    v_fma_f32 v42, v26, s44, v15
    v_fma_f32 v35, v27, s44, v14
    v_fma_f32 v43, v27, s44, v15
    v_fma_f32 v36, v28, s44, v14
    v_fma_f32 v44, v28, s44, v15
    v_fma_f32 v37, v29, s44, v14
    v_fma_f32 v45, v29, s44, v15
    v_fma_f32 v38, v30, s44, v14
    v_fma_f32 v46, v30, s44, v15
    v_fma_f32 v39, v31, s44, v14
    v_fma_f32 v47, v31, s44, v15
    v_cos_f32 v32, v32
    v_cos_f32 v33, v33
    v_cos_f32 v34, v34
    v_cos_f32 v35, v35
    v_cos_f32 v36, v36
    v_cos_f32 v37, v37
    v_cos_f32 v38, v38
    v_cos_f32 v39, v39
    v_cos_f32 v40, v40
    v_cos_f32 v41, v41
    v_cos_f32 v42, v42
    v_cos_f32 v43, v43
    v_cos_f32 v44, v44
    v_cos_f32 v45, v45
    v_cos_f32 v46, v46
    v_cos_f32 v47, v47
    v_mul_f32 v32, v32, v16
    v_mul_f32 v40, v40, v17
    v_mul_f32 v33, v33, v16
    v_mul_f32 v41, v41, v17
    v_mul_f32 v34, v34, v16
    v_mul_f32 v42, v42, v17
    v_mul_f32 v35, v35, v16
    v_mul_f32 v43, v43, v17
    v_mul_f32 v36, v36, v16
    v_mul_f32 v44, v44, v17
    v_mul_f32 v37, v37, v16
    v_mul_f32 v45, v45, v17
    v_mul_f32 v38, v38, v16
    v_mul_f32 v46, v46, v17
    v_mul_f32 v39, v39, v16
    v_mul_f32 v47, v47, v17
    v_cvt_pk_f16_f32 v140, v32, v33
    v_cvt_pk_f16_f32 v141, v34, v35
    v_cvt_pk_f16_f32 v142, v36, v37
    v_cvt_pk_f16_f32 v143, v38, v39
    v_cvt_pk_f16_f32 v144, v40, v41
    v_cvt_pk_f16_f32 v145, v42, v43
    v_cvt_pk_f16_f32 v146, v44, v45
    v_cvt_pk_f16_f32 v147, v46, v47
    v_bfe_u32 v23, v2, 2, 3
    v_lshlrev_b32 v23, 1, v23
    v_bfe_u32 v24, v2, 1, 1
    s_lshl_b32 s26, s6, 2
    v_add_u32 v24, s26, v24
    v_add_u32 v25, 2, v24
    v_xor_b32 v24, v24, v23
    v_xor_b32 v25, v25, v23
    v_mul_u32_u24 v22, 5120, v3
    v_bfe_u32 v26, v2, 2, 2
    v_lshl_add_u32 v22, v26, 8, v22
    v_and_b32 v26, 1, v2
    v_lshl_add_u32 v22, v26, 3, v22
    v_lshl_add_u32 v24, v24, 4, v22
    v_lshl_add_u32 v25, v25, 4, v22
    v_add_u32 v26, 40960, v24
    v_add_u32 v27, 40960, v25
    v_mul_u32_u24 v20, 1312, v4
    s_lshl_b32 s26, s6, 6
    v_lshl_add_u32 v20, v3, 3, v20
    v_add_u32 v20, s26, v20
    v_lshrrev_b32 v21, 5, v2
    v_bfe_u32 v22, v2, 2, 2
    v_lshl_add_u32 v21, v21, 3, v22
    v_mul_u32_u24 v21, 40, v21
    v_bfe_u32 v22, v2, 4, 1
    v_lshl_add_u32 v21, v22, 5, v21
    v_and_b32 v22, 3, v2
    v_lshl_add_u32 v21, v22, 3, v21
    s_mul_i32 s26, s6, 2624
    v_add_u32 v21, s26, v21
    v_add_u32 v28, 81920, v6
    s_waitcnt vmcnt(3)
    s_barrier
    s_cmp_eq_u32 s6, 4
    s_cbranch_scc1 L_kb_skipB
    ds_read_b64_tr_b16 v[56:57], v24 offset:0
    ds_read_b64_tr_b16 v[58:59], v24 offset:20480
    ds_read_b64_tr_b16 v[60:61], v26 offset:0
    ds_read_b64_tr_b16 v[62:63], v26 offset:20480
    ds_read_b64_tr_b16 v[64:65], v25 offset:0
    ds_read_b64_tr_b16 v[66:67], v25 offset:20480
    ds_read_b64_tr_b16 v[68:69], v27 offset:0
    ds_read_b64_tr_b16 v[70:71], v27 offset:20480
    ds_read_b64_tr_b16 v[72:73], v24 offset:1024
    ds_read_b64_tr_b16 v[74:75], v24 offset:21504
    ds_read_b64_tr_b16 v[76:77], v26 offset:1024
    ds_read_b64_tr_b16 v[78:79], v26 offset:21504
    ds_read_b64_tr_b16 v[80:81], v25 offset:1024
    ds_read_b64_tr_b16 v[82:83], v25 offset:21504
    ds_read_b64_tr_b16 v[84:85], v27 offset:1024
    ds_read_b64_tr_b16 v[86:87], v27 offset:21504
    ds_read_b64_tr_b16 v[88:89], v24 offset:2048
    ds_read_b64_tr_b16 v[90:91], v24 offset:22528
    ds_read_b64_tr_b16 v[92:93], v26 offset:2048
    ds_read_b64_tr_b16 v[94:95], v26 offset:22528
    ds_read_b64_tr_b16 v[96:97], v25 offset:2048
    ds_read_b64_tr_b16 v[98:99], v25 offset:22528
    ds_read_b64_tr_b16 v[100:101], v27 offset:2048
    ds_read_b64_tr_b16 v[102:103], v27 offset:22528
    ds_read_b64_tr_b16 v[104:105], v24 offset:3072
    ds_read_b64_tr_b16 v[106:107], v24 offset:23552
    ds_read_b64_tr_b16 v[108:109], v26 offset:3072
    ds_read_b64_tr_b16 v[110:111], v26 offset:23552
    ds_read_b64_tr_b16 v[112:113], v25 offset:3072
    ds_read_b64_tr_b16 v[114:115], v25 offset:23552
    ds_read_b64_tr_b16 v[116:117], v27 offset:3072
    ds_read_b64_tr_b16 v[118:119], v27 offset:23552
    ds_read_b64_tr_b16 v[120:121], v24 offset:4096
    ds_read_b64_tr_b16 v[122:123], v24 offset:24576
    ds_read_b64_tr_b16 v[124:125], v26 offset:4096
    ds_read_b64_tr_b16 v[126:127], v26 offset:24576
    ds_read_b64_tr_b16 v[128:129], v25 offset:4096
    ds_read_b64_tr_b16 v[130:131], v25 offset:24576
    ds_read_b64_tr_b16 v[132:133], v27 offset:4096
    ds_read_b64_tr_b16 v[134:135], v27 offset:24576
    s_waitcnt lgkmcnt(15)
    v_mfma_f32_16x16x32_f16 v[164:167], v[56:59], v[140:143], 0
    v_mfma_f32_16x16x32_f16 v[164:167], v[60:63], v[144:147], v[164:167]
    s_waitcnt lgkmcnt(15)
    v_mfma_f32_16x16x32_f16 v[168:171], v[64:67], v[140:143], 0
    v_mfma_f32_16x16x32_f16 v[168:171], v[68:71], v[144:147], v[168:171]
    s_waitcnt lgkmcnt(15)
    v_mfma_f32_16x16x32_f16 v[172:175], v[72:75], v[140:143], 0
    v_mfma_f32_16x16x32_f16 v[172:175], v[76:79], v[144:147], v[172:175]
    s_waitcnt lgkmcnt(15)
    v_mfma_f32_16x16x32_f16 v[176:179], v[80:83], v[140:143], 0
    v_mfma_f32_16x16x32_f16 v[176:179], v[84:87], v[144:147], v[176:179]
    s_waitcnt lgkmcnt(15)
    v_mfma_f32_16x16x32_f16 v[180:183], v[88:91], v[140:143], 0
    v_mfma_f32_16x16x32_f16 v[180:183], v[92:95], v[144:147], v[180:183]
    s_waitcnt lgkmcnt(15)
    v_mfma_f32_16x16x32_f16 v[184:187], v[96:99], v[140:143], 0
    v_mfma_f32_16x16x32_f16 v[184:187], v[100:103], v[144:147], v[184:187]
    s_waitcnt lgkmcnt(12)
    v_mfma_f32_16x16x32_f16 v[188:191], v[104:107], v[140:143], 0
    v_mfma_f32_16x16x32_f16 v[188:191], v[108:111], v[144:147], v[188:191]
    s_waitcnt lgkmcnt(8)
    v_mfma_f32_16x16x32_f16 v[192:195], v[112:115], v[140:143], 0
    v_mfma_f32_16x16x32_f16 v[192:195], v[116:119], v[144:147], v[192:195]
    s_waitcnt lgkmcnt(4)
    v_mfma_f32_16x16x32_f16 v[196:199], v[120:123], v[140:143], 0
    v_mfma_f32_16x16x32_f16 v[196:199], v[124:127], v[144:147], v[196:199]
    s_waitcnt lgkmcnt(0)
    v_mfma_f32_16x16x32_f16 v[200:203], v[128:131], v[140:143], 0
    v_mfma_f32_16x16x32_f16 v[200:203], v[132:135], v[144:147], v[200:203]
    v_cvt_pk_f16_f32 v56, v164, v165
    v_cvt_pk_f16_f32 v57, v166, v167
    v_cvt_pk_f16_f32 v58, v168, v169
    v_cvt_pk_f16_f32 v59, v170, v171
    v_cvt_pk_f16_f32 v60, v172, v173
    v_cvt_pk_f16_f32 v61, v174, v175
    v_cvt_pk_f16_f32 v62, v176, v177
    v_cvt_pk_f16_f32 v63, v178, v179
    v_cvt_pk_f16_f32 v64, v180, v181
    v_cvt_pk_f16_f32 v65, v182, v183
    v_cvt_pk_f16_f32 v66, v184, v185
    v_cvt_pk_f16_f32 v67, v186, v187
    v_cvt_pk_f16_f32 v68, v188, v189
    v_cvt_pk_f16_f32 v69, v190, v191
    v_cvt_pk_f16_f32 v70, v192, v193
    v_cvt_pk_f16_f32 v71, v194, v195
    v_cvt_pk_f16_f32 v72, v196, v197
    v_cvt_pk_f16_f32 v73, v198, v199
    v_cvt_pk_f16_f32 v74, v200, v201
    v_cvt_pk_f16_f32 v75, v202, v203
L_kb_skipB:
    s_barrier
    s_cmp_eq_u32 s6, 4
    s_cbranch_scc1 L_kb_skipY
    v_cmp_gt_u32 vcc, 10, v4
    s_and_saveexec_b64 s[46:47], vcc
    ds_write_b64 v20, v[56:57] offset:0
    ds_write_b64 v20, v[58:59] offset:32
    ds_write_b64 v20, v[60:61] offset:256
    ds_write_b64 v20, v[62:63] offset:288
    ds_write_b64 v20, v[64:65] offset:512
    ds_write_b64 v20, v[66:67] offset:544
    ds_write_b64 v20, v[68:69] offset:768
    ds_write_b64 v20, v[70:71] offset:800
    ds_write_b64 v20, v[72:73] offset:1024
    ds_write_b64 v20, v[74:75] offset:1056
    s_mov_b64 exec, s[46:47]
L_kb_skipY:
    ds_read_b128 v[164:167], v28 offset:0
    ds_read_b128 v[168:171], v28 offset:1024
    ds_read_b128 v[172:175], v28 offset:2048
    ds_read_b128 v[176:179], v28 offset:3072
    ds_read_b128 v[180:183], v28 offset:4096
    ds_read_b128 v[184:187], v28 offset:5120
    s_waitcnt lgkmcnt(6)
    s_barrier
    ds_read_b64_tr_b16 v[56:57], v21 offset:0
    ds_read_b64_tr_b16 v[58:59], v21 offset:160
    ds_read_b64_tr_b16 v[60:61], v21 offset:640
    ds_read_b64_tr_b16 v[62:63], v21 offset:800
    ds_read_b64_tr_b16 v[64:65], v21 offset:1312
    ds_read_b64_tr_b16 v[66:67], v21 offset:1472
    ds_read_b64_tr_b16 v[68:69], v21 offset:1952
    ds_read_b64_tr_b16 v[70:71], v21 offset:2112
    ds_read_b128 v[188:191], v28 offset:6144
    ds_read_b128 v[192:195], v28 offset:7168
    ds_read_b128 v[196:199], v28 offset:8192
    ds_read_b128 v[200:203], v28 offset:9216
    ds_read_b128 v[204:207], v28 offset:10240
    ds_read_b128 v[208:211], v28 offset:11264
    ds_read_b128 v[212:215], v28 offset:12288
    ds_read_b128 v[216:219], v28 offset:13312
    ds_read_b128 v[220:223], v28 offset:14336
    s_waitcnt lgkmcnt(9)
    v_mfma_f32_32x32x16_f16 v[72:87], v[56:59], v[164:167], 0
    v_mfma_f32_32x32x16_f16 v[88:103], v[64:67], v[164:167], 0
    v_mfma_f32_32x32x16_f16 v[72:87], v[60:63], v[168:171], v[72:87]
    v_mfma_f32_32x32x16_f16 v[88:103], v[68:71], v[168:171], v[88:103]
    v_mfma_f32_32x32x16_f16 v[72:87], v[64:67], v[172:175], v[72:87]
    v_mfma_f32_32x32x16_f16 v[88:103], v[56:59], v[180:183], v[88:103]
    v_mfma_f32_32x32x16_f16 v[72:87], v[68:71], v[176:179], v[72:87]
    v_mfma_f32_32x32x16_f16 v[88:103], v[60:63], v[184:187], v[88:103]
    s_mul_i32 s26, s6, 6144
    s_add_u32 s26, s26, 16384
    v_and_b32 v22, 31, v2
    v_lshrrev_b32 v23, 5, v2
    v_mul_u32_u24 v24, 144, v22
    v_lshl_add_u32 v24, v23, 4, v24
    s_add_u32 s27, s26, 5680
    v_sub_u32 v25, s27, v24
    v_add_u32 v24, s26, v24
    v_lshlrev_b32 v26, 4, v23
    v_sub_u32 v26, 16, v26
    v_add_u32 v26, v25, v26
    v_lshrrev_b32 v27, 2, v8
    v_mul_u32_u24 v27, 144, v27
    v_and_b32 v29, 3, v8
    v_lshl_add_u32 v27, v29, 5, v27
    v_mul_u32_u24 v29, 2944, v23
    v_add3_u32 v27, v27, v29, s26
    v_add_u32 v29, 2304, v27
    v_cndmask_b32 v29, v27, v29, s[42:43]
    s_waitcnt lgkmcnt(0)
    v_pk_mul_f32 v[104:105], v[72:73], v[188:189]
    v_pk_mul_f32 v[106:107], v[74:75], v[190:191]
    v_pk_mul_f32 v[108:109], v[76:77], v[192:193]
    v_pk_mul_f32 v[110:111], v[78:79], v[194:195]
    v_pk_mul_f32 v[112:113], v[80:81], v[196:197]
    v_pk_mul_f32 v[114:115], v[82:83], v[198:199]
    v_pk_mul_f32 v[116:117], v[88:89], v[188:189]
    v_pk_mul_f32 v[118:119], v[90:91], v[190:191]
    v_pk_mul_f32 v[120:121], v[92:93], v[192:193]
    v_pk_mul_f32 v[122:123], v[94:95], v[194:195]
    v_pk_mul_f32 v[124:125], v[96:97], v[196:197]
    v_pk_mul_f32 v[126:127], v[98:99], v[198:199]
    v_pk_fma_f32 v[104:105], v[88:89], v[200:201], v[104:105]
    v_pk_fma_f32 v[106:107], v[90:91], v[202:203], v[106:107]
    v_pk_fma_f32 v[108:109], v[92:93], v[204:205], v[108:109]
    v_pk_fma_f32 v[110:111], v[94:95], v[206:207], v[110:111]
    v_pk_fma_f32 v[112:113], v[96:97], v[208:209], v[112:113]
    v_pk_fma_f32 v[114:115], v[98:99], v[210:211], v[114:115]
    v_pk_fma_f32 v[116:117], v[72:73], v[200:201], v[116:117] neg_lo:[1,0,0] neg_hi:[1,0,0]
    v_pk_fma_f32 v[118:119], v[74:75], v[202:203], v[118:119] neg_lo:[1,0,0] neg_hi:[1,0,0]
    v_pk_fma_f32 v[120:121], v[76:77], v[204:205], v[120:121] neg_lo:[1,0,0] neg_hi:[1,0,0]
    v_pk_fma_f32 v[122:123], v[78:79], v[206:207], v[122:123] neg_lo:[1,0,0] neg_hi:[1,0,0]
    v_pk_fma_f32 v[124:125], v[80:81], v[208:209], v[124:125] neg_lo:[1,0,0] neg_hi:[1,0,0]
    v_pk_fma_f32 v[126:127], v[82:83], v[210:211], v[126:127] neg_lo:[1,0,0] neg_hi:[1,0,0]
    v_cvt_pk_f16_f32 v56, v104, v105
    v_cvt_pk_f16_f32 v57, v106, v107
    v_cvt_pk_f16_f32 v58, v108, v109
    v_cvt_pk_f16_f32 v59, v110, v111
    v_cvt_pk_f16_f32 v60, v116, v117
    v_cvt_pk_f16_f32 v61, v118, v119
    v_cvt_pk_f16_f32 v62, v120, v121
    v_cvt_pk_f16_f32 v63, v122, v123
    v_cvt_pk_f16_f32 v64, v112, v113
    v_cvt_pk_f16_f32 v65, v114, v115
    v_cvt_pk_f16_f32 v66, v124, v125
    v_cvt_pk_f16_f32 v67, v126, v127
    v_mfma_f32_32x32x16_f16 v[72:87], v[56:59], v[212:215], 0
    v_mfma_f32_32x32x16_f16 v[72:87], v[60:63], v[216:219], v[72:87]
    v_mfma_f32_32x32x16_f16 v[72:87], v[64:67], v[220:223], v[72:87]
    s_mov_b64 s[48:49], -1
    s_and_b32 s27, s40, 1023
    s_cmp_eq_u32 s27, 0
    s_cselect_b32 s49, 0, s49
    s_and_b64 s[50:51], s[48:49], s[42:43]
    s_mov_b32 s52, 0x3f803f80
    s_mov_b32 s53, 0x3acccccd
    s_mov_b32 s54, 16384
    s_mov_b32 s55, 32768
    v_cmp_gt_u32 vcc, 20, v22
    s_and_saveexec_b64 s[46:47], vcc
    s_nop 0
    ds_write_b128 v24, v[72:75] offset:0
    ds_write_b128 v24, v[76:79] offset:32
    ds_write_b128 v24, v[80:83] offset:64
    ds_write_b128 v24, v[84:87] offset:96
    ds_write_b32 v26, v72 offset:128
    ds_write_b32 v25, v73 offset:124
    ds_write_b32 v25, v74 offset:120
    ds_write_b32 v25, v75 offset:116
    ds_write_b32 v25, v76 offset:96
    ds_write_b32 v25, v77 offset:92
    ds_write_b32 v25, v78 offset:88
    ds_write_b32 v25, v79 offset:84
    ds_write_b32 v25, v80 offset:64
    ds_write_b32 v25, v81 offset:60
    ds_write_b32 v25, v82 offset:56
    ds_write_b32 v25, v83 offset:52
    ds_write_b32 v25, v84 offset:32
    ds_write_b32 v25, v85 offset:28
    ds_write_b32 v25, v86 offset:24
    ds_write_b32 v25, v87 offset:20
    v_cmp_eq_u32 vcc, 0, v2
    s_and_b64 exec, exec, vcc
    ds_write_b32 v24, v72 offset:2944
    s_mov_b64 exec, s[46:47]
    s_waitcnt vmcnt(0)
    v_lshlrev_b32 v104, 16, v152
    v_and_b32 v105, 0xffff0000, v152
    v_lshlrev_b32 v106, 16, v153
    v_and_b32 v107, 0xffff0000, v153
    v_lshlrev_b32 v108, 16, v154
    v_and_b32 v109, 0xffff0000, v154
    v_lshlrev_b32 v110, 16, v155
    v_and_b32 v111, 0xffff0000, v155
    v_lshlrev_b32 v112, 16, v156
    v_and_b32 v113, 0xffff0000, v156
    v_lshlrev_b32 v114, 16, v157
    v_and_b32 v115, 0xffff0000, v157
    v_lshlrev_b32 v116, 16, v158
    v_and_b32 v117, 0xffff0000, v158
    v_lshlrev_b32 v118, 16, v159
    v_and_b32 v119, 0xffff0000, v159
    v_lshlrev_b32 v120, 16, v160
    v_and_b32 v121, 0xffff0000, v160
    v_lshlrev_b32 v122, 16, v161
    v_and_b32 v123, 0xffff0000, v161
    v_lshlrev_b32 v124, 16, v162
    v_and_b32 v125, 0xffff0000, v162
    v_lshlrev_b32 v126, 16, v163
    v_and_b32 v127, 0xffff0000, v163
    s_waitcnt lgkmcnt(0)
    ds_read_b128 v[56:59], v27
    ds_read_b128 v[60:63], v27 offset:16
    ds_read_b128 v[64:67], v27 offset:1152
    ds_read_b128 v[68:71], v27 offset:1168
    ds_read_b128 v[72:75], v29
    ds_read_b128 v[76:79], v29 offset:16
    v_mov_b32 v32, 0
    v_mov_b32 v33, 0
    v_mov_b32 v34, 0
    v_mov_b32 v35, 0
    s_waitcnt lgkmcnt(5)
    v_pk_add_f32 v[56:57], v[56:57], v[104:105]
    v_pk_add_f32 v[58:59], v[58:59], v[106:107]
    s_waitcnt lgkmcnt(4)
    v_pk_add_f32 v[60:61], v[60:61], v[108:109]
    v_pk_add_f32 v[62:63], v[62:63], v[110:111]
    s_waitcnt lgkmcnt(3)
    v_pk_add_f32 v[64:65], v[64:65], v[112:113]
    v_pk_add_f32 v[66:67], v[66:67], v[114:115]
    s_waitcnt lgkmcnt(2)
    v_pk_add_f32 v[68:69], v[68:69], v[116:117]
    v_pk_add_f32 v[70:71], v[70:71], v[118:119]
    s_waitcnt lgkmcnt(1)
    v_pk_add_f32 v[72:73], v[72:73], v[120:121]
    v_pk_add_f32 v[74:75], v[74:75], v[122:123]
    s_waitcnt lgkmcnt(0)
    v_pk_add_f32 v[76:77], v[76:77], v[124:125]
    v_pk_add_f32 v[78:79], v[78:79], v[126:127]
    v_cvt_pk_bf16_f32 v80, v56, v57
    v_cvt_pk_bf16_f32 v81, v58, v59
    v_cvt_pk_bf16_f32 v82, v60, v61
    v_cvt_pk_bf16_f32 v83, v62, v63
    v_cvt_pk_bf16_f32 v84, v64, v65
    v_cvt_pk_bf16_f32 v85, v66, v67
    v_cvt_pk_bf16_f32 v86, v68, v69
    v_cvt_pk_bf16_f32 v87, v70, v71
    v_cvt_pk_bf16_f32 v88, v72, v73
    v_cvt_pk_bf16_f32 v89, v74, v75
    v_cvt_pk_bf16_f32 v90, v76, v77
    v_cvt_pk_bf16_f32 v91, v78, v79
    v_dot2c_f32_bf16 v32, s52, v80
    v_dot2c_f32_bf16 v33, v80, v80
    v_dot2c_f32_bf16 v32, s52, v81
    v_dot2c_f32_bf16 v33, v81, v81
    v_dot2c_f32_bf16 v32, s52, v82
    v_dot2c_f32_bf16 v33, v82, v82
    v_dot2c_f32_bf16 v32, s52, v83
    v_dot2c_f32_bf16 v33, v83, v83
    v_dot2c_f32_bf16 v32, s52, v84
    v_dot2c_f32_bf16 v33, v84, v84
    v_dot2c_f32_bf16 v32, s52, v85
    v_dot2c_f32_bf16 v33, v85, v85
    v_dot2c_f32_bf16 v32, s52, v86
    v_dot2c_f32_bf16 v33, v86, v86
    v_dot2c_f32_bf16 v32, s52, v87
    v_dot2c_f32_bf16 v33, v87, v87
    v_dot2c_f32_bf16 v34, s52, v88
    v_dot2c_f32_bf16 v35, v88, v88
    v_dot2c_f32_bf16 v34, s52, v89
    v_dot2c_f32_bf16 v35, v89, v89
    v_dot2c_f32_bf16 v34, s52, v90
    v_dot2c_f32_bf16 v35, v90, v90
    v_dot2c_f32_bf16 v34, s52, v91
    v_dot2c_f32_bf16 v35, v91, v91
    v_lshlrev_b32 v56, 16, v80
    v_and_b32 v57, 0xffff0000, v80
    v_lshlrev_b32 v58, 16, v81
    v_and_b32 v59, 0xffff0000, v81
    v_lshlrev_b32 v60, 16, v82
    v_and_b32 v61, 0xffff0000, v82
    v_lshlrev_b32 v62, 16, v83
    v_and_b32 v63, 0xffff0000, v83
    v_lshlrev_b32 v64, 16, v84
    v_and_b32 v65, 0xffff0000, v84
    v_lshlrev_b32 v66, 16, v85
    v_and_b32 v67, 0xffff0000, v85
    v_lshlrev_b32 v68, 16, v86
    v_and_b32 v69, 0xffff0000, v86
    v_lshlrev_b32 v70, 16, v87
    v_and_b32 v71, 0xffff0000, v87
    v_lshlrev_b32 v72, 16, v88
    v_and_b32 v73, 0xffff0000, v88
    v_lshlrev_b32 v74, 16, v89
    v_and_b32 v75, 0xffff0000, v89
    v_lshlrev_b32 v76, 16, v90
    v_and_b32 v77, 0xffff0000, v90
    v_lshlrev_b32 v78, 16, v91
    v_and_b32 v79, 0xffff0000, v91
    v_cndmask_b32 v34, 0, v34, s[42:43]
    v_cndmask_b32 v35, 0, v35, s[42:43]
    v_pk_add_f32 v[32:33], v[32:33], v[34:35]
    s_nop 1
    v_add_f32_dpp v32, v32, v32 row_ror:8 row_mask:0xf bank_mask:0xf
    v_add_f32_dpp v33, v33, v33 row_ror:8 row_mask:0xf bank_mask:0xf
    s_nop 0
    v_add_f32_dpp v32, v32, v32 row_ror:4 row_mask:0xf bank_mask:0xf
    v_add_f32_dpp v33, v33, v33 row_ror:4 row_mask:0xf bank_mask:0xf
    s_nop 0
    v_add_f32_dpp v32, v32, v32 row_ror:2 row_mask:0xf bank_mask:0xf
    v_add_f32_dpp v33, v33, v33 row_ror:2 row_mask:0xf bank_mask:0xf
    s_nop 0
    v_add_f32_dpp v32, v32, v32 row_ror:1 row_mask:0xf bank_mask:0xf
    v_add_f32_dpp v33, v33, v33 row_ror:1 row_mask:0xf bank_mask:0xf
    ds_swizzle_b32 v34, v32 offset:0x401F
    ds_swizzle_b32 v35, v33 offset:0x401F
    s_mov_b64 exec, s[48:49]
    buffer_store_dwordx4 v[80:83], v9, s[32:35], 0 offen
    buffer_store_dwordx4 v[84:87], v9, s[32:35], 0 offen offset:512
    s_mov_b64 exec, s[50:51]
    buffer_store_dwordx4 v[88:91], v9, s[32:35], 0 offen offset:1024
    s_mov_b64 exec, -1
    s_waitcnt lgkmcnt(0)
    v_pk_add_f32 v[32:33], v[32:33], v[34:35]
    v_mul_f32 v32, s53, v32
    v_mul_f32 v33, s53, v33
    v_fma_f32 v33, -v32, v32, v33
    v_max_f32 v33, 0, v33
    v_cvt_pk_bf16_f32 v32, v32, v32
    v_lshlrev_b32 v32, 16, v32
    v_cvt_pk_bf16_f32 v34, v33, v33
    v_lshlrev_b32 v34, 16, v34
    v_add_f32 v34, 0x3727c5ac, v34
    v_cvt_pk_bf16_f32 v34, v34, v34
    v_lshlrev_b32 v34, 16, v34
    v_sqrt_f32 v34, v34
    s_nop 0
    v_cvt_pk_bf16_f32 v34, v34, v34
    v_lshlrev_b32 v34, 16, v34
    v_rcp_f32 v34, v34
    v_pk_add_f32 v[104:105], v[56:57], v[32:33] op_sel_hi:[1,0] neg_lo:[0,1] neg_hi:[0,1]
    v_pk_add_f32 v[106:107], v[58:59], v[32:33] op_sel_hi:[1,0] neg_lo:[0,1] neg_hi:[0,1]
    v_pk_add_f32 v[108:109], v[60:61], v[32:33] op_sel_hi:[1,0] neg_lo:[0,1] neg_hi:[0,1]
    v_pk_add_f32 v[110:111], v[62:63], v[32:33] op_sel_hi:[1,0] neg_lo:[0,1] neg_hi:[0,1]
    v_pk_add_f32 v[112:113], v[64:65], v[32:33] op_sel_hi:[1,0] neg_lo:[0,1] neg_hi:[0,1]
    v_pk_add_f32 v[114:115], v[66:67], v[32:33] op_sel_hi:[1,0] neg_lo:[0,1] neg_hi:[0,1]
    v_pk_add_f32 v[116:117], v[68:69], v[32:33] op_sel_hi:[1,0] neg_lo:[0,1] neg_hi:[0,1]
    v_pk_add_f32 v[118:119], v[70:71], v[32:33] op_sel_hi:[1,0] neg_lo:[0,1] neg_hi:[0,1]
    v_pk_add_f32 v[120:121], v[72:73], v[32:33] op_sel_hi:[1,0] neg_lo:[0,1] neg_hi:[0,1]
    v_pk_add_f32 v[122:123], v[74:75], v[32:33] op_sel_hi:[1,0] neg_lo:[0,1] neg_hi:[0,1]
    v_pk_add_f32 v[124:125], v[76:77], v[32:33] op_sel_hi:[1,0] neg_lo:[0,1] neg_hi:[0,1]
    v_pk_add_f32 v[126:127], v[78:79], v[32:33] op_sel_hi:[1,0] neg_lo:[0,1] neg_hi:[0,1]
    v_cvt_pk_bf16_f32 v92, v104, v105
    v_cvt_pk_bf16_f32 v93, v106, v107
    v_cvt_pk_bf16_f32 v94, v108, v109
    v_cvt_pk_bf16_f32 v95, v110, v111
    v_cvt_pk_bf16_f32 v96, v112, v113
    v_cvt_pk_bf16_f32 v97, v114, v115
    v_cvt_pk_bf16_f32 v98, v116, v117
    v_cvt_pk_bf16_f32 v99, v118, v119
    v_cvt_pk_bf16_f32 v100, v120, v121
    v_cvt_pk_bf16_f32 v101, v122, v123
    v_cvt_pk_bf16_f32 v102, v124, v125
    v_cvt_pk_bf16_f32 v103, v126, v127
    v_lshlrev_b32 v104, 16, v92
    v_and_b32 v105, 0xffff0000, v92
    v_lshlrev_b32 v106, 16, v93
    v_and_b32 v107, 0xffff0000, v93
    v_lshlrev_b32 v108, 16, v94
    v_and_b32 v109, 0xffff0000, v94
    v_lshlrev_b32 v110, 16, v95
    v_and_b32 v111, 0xffff0000, v95
    v_lshlrev_b32 v112, 16, v96
    v_and_b32 v113, 0xffff0000, v96
    v_lshlrev_b32 v114, 16, v97
    v_and_b32 v115, 0xffff0000, v97
    v_lshlrev_b32 v116, 16, v98
    v_and_b32 v117, 0xffff0000, v98
    v_lshlrev_b32 v118, 16, v99
    v_and_b32 v119, 0xffff0000, v99
    v_lshlrev_b32 v120, 16, v100
    v_and_b32 v121, 0xffff0000, v100
    v_lshlrev_b32 v122, 16, v101
    v_and_b32 v123, 0xffff0000, v101
    v_lshlrev_b32 v124, 16, v102
    v_and_b32 v125, 0xffff0000, v102
    v_lshlrev_b32 v126, 16, v103
    v_and_b32 v127, 0xffff0000, v103
    v_pk_mul_f32 v[104:105], v[104:105], v[34:35] op_sel_hi:[1,0]
    v_pk_mul_f32 v[106:107], v[106:107], v[34:35] op_sel_hi:[1,0]
    v_pk_mul_f32 v[108:109], v[108:109], v[34:35] op_sel_hi:[1,0]
    v_pk_mul_f32 v[110:111], v[110:111], v[34:35] op_sel_hi:[1,0]
    v_pk_mul_f32 v[112:113], v[112:113], v[34:35] op_sel_hi:[1,0]
    v_pk_mul_f32 v[114:115], v[114:115], v[34:35] op_sel_hi:[1,0]
    v_pk_mul_f32 v[116:117], v[116:117], v[34:35] op_sel_hi:[1,0]
    v_pk_mul_f32 v[118:119], v[118:119], v[34:35] op_sel_hi:[1,0]
    v_pk_mul_f32 v[120:121], v[120:121], v[34:35] op_sel_hi:[1,0]
    v_pk_mul_f32 v[122:123], v[122:123], v[34:35] op_sel_hi:[1,0]
    v_pk_mul_f32 v[124:125], v[124:125], v[34:35] op_sel_hi:[1,0]
    v_pk_mul_f32 v[126:127], v[126:127], v[34:35] op_sel_hi:[1,0]
    v_cvt_pk_bf16_f32 v92, v104, v105
    v_cvt_pk_bf16_f32 v93, v106, v107
    v_cvt_pk_bf16_f32 v94, v108, v109
    v_cvt_pk_bf16_f32 v95, v110, v111
    v_cvt_pk_bf16_f32 v96, v112, v113
    v_cvt_pk_bf16_f32 v97, v114, v115
    v_cvt_pk_bf16_f32 v98, v116, v117
    v_cvt_pk_bf16_f32 v99, v118, v119
    v_cvt_pk_bf16_f32 v100, v120, v121
    v_cvt_pk_bf16_f32 v101, v122, v123
    v_cvt_pk_bf16_f32 v102, v124, v125
    v_cvt_pk_bf16_f32 v103, v126, v127
    s_mov_b64 exec, s[48:49]
    buffer_store_dwordx4 v[92:95], v11, s[36:39], 0 offen
    buffer_store_dwordx4 v[96:99], v11, s[36:39], s54 offen
    s_mov_b64 exec, s[50:51]
    buffer_store_dwordx4 v[100:103], v11, s[36:39], s55 offen
    s_mov_b64 exec, -1
L_kb_end:
    s_endpgm
.p2align 8
T_kb:
.long 0x3c003c00, 0x3c003c00, 0x3c003c00, 0x3c003c00, 0x3bd93c00, 0x3aa73b64, 0x387239a8, 0x323e361f
.long 0x3b643c00, 0x361f39a8, 0xb61f0000, 0xbb64b9a8, 0x3aa73c00, 0xb23e361f, 0xbbd9b9a8, 0xb872bb64
.long 0x39a83c00, 0xb9a80000, 0xb9a8bc00, 0x39a88000, 0x38723c00, 0xbbd9b61f, 0x323eb9a8, 0x3aa73b64
.long 0x361f3c00, 0xbb64b9a8, 0x3b648000, 0xb61f39a8, 0x323e3c00, 0xb872bb64, 0x3aa739a8, 0xbbd9b61f
.long 0x00003c00, 0x8000bc00, 0x00003c00, 0x8000bc00, 0xb23e3c00, 0x3872bb64, 0xbaa739a8, 0x3bd9b61f
.long 0xb61f3c00, 0x3b64b9a8, 0xbb640000, 0x361f39a8, 0xb8723c00, 0x3bd9b61f, 0xb23eb9a8, 0xbaa73b64
.long 0xb9a83c00, 0x39a88000, 0x39a8bc00, 0xb9a80000, 0xbaa73c00, 0x323e361f, 0x3bd9b9a8, 0x3872bb64
.long 0xbb643c00, 0xb61f39a8, 0x361f8000, 0x3b64b9a8, 0xbbd93c00, 0xbaa73b64, 0xb87239a8, 0xb23e361f
.long 0xbc003c00, 0xbc003c00, 0xbc003c00, 0xbc003c00, 0xbbd93c00, 0xbaa73b64, 0xb87239a8, 0xb23e361f
.long 0xbb643c00, 0xb61f39a8, 0x361f0000, 0x3b64b9a8, 0xbaa73c00, 0x323e361f, 0x3bd9b9a8, 0x3872bb64
.long 0xb9a83c00, 0x39a80000, 0x39a8bc00, 0xb9a88000, 0xb8723c00, 0x3bd9b61f, 0xb23eb9a8, 0xbaa73b64
.long 0xb61f3c00, 0x3b64b9a8, 0xbb648000, 0x361f39a8, 0xb23e3c00, 0x3872bb64, 0xbaa739a8, 0x3bd9b61f
.long 0x80003c00, 0x0000bc00, 0x80003c00, 0x0000bc00, 0x323e3c00, 0xb872bb64, 0x3aa739a8, 0xbbd9b61f
.long 0x361f3c00, 0xbb64b9a8, 0x3b640000, 0xb61f39a8, 0x38723c00, 0xbbd9b61f, 0x323eb9a8, 0x3aa73b64
.long 0x39a83c00, 0xb9a88000, 0xb9a8bc00, 0x39a80000, 0x3aa73c00, 0xb23e361f, 0xbbd9b9a8, 0xb872bb64
.long 0x3b643c00, 0x361f39a8, 0xb61f8000, 0xbb64b9a8, 0x3bd93c00, 0x3aa73b64, 0x387239a8, 0x323e361f
.long 0x3c003c00, 0x3c003c00, 0x3c003c00, 0x3c003c00, 0xb23e0000, 0xb872b61f, 0xbaa7b9a8, 0xbbd9bb64
.long 0xbb64bc00, 0xb61fb9a8, 0x361f8000, 0x3b6439a8, 0x38728000, 0x3bd93b64, 0x323e39a8, 0xbaa7b61f
.long 0x39a83c00, 0xb9a80000, 0xb9a8bc00, 0x39a88000, 0xbaa70000, 0xb23ebb64, 0x3bd939a8, 0xb872361f
.long 0xb61fbc00, 0x3b6439a8, 0xbb640000, 0x361fb9a8, 0x3bd98000, 0xbaa7361f, 0x3872b9a8, 0xb23e3b64
.long 0x00003c00, 0x8000bc00, 0x00003c00, 0x8000bc00, 0xbbd90000, 0x3aa7361f, 0xb872b9a8, 0x323e3b64
.long 0x361fbc00, 0xbb6439a8, 0x3b648000, 0xb61fb9a8, 0x3aa78000, 0x323ebb64, 0xbbd939a8, 0x3872361f
.long 0xb9a83c00, 0x39a88000, 0x39a8bc00, 0xb9a80000, 0xb8720000, 0xbbd93b64, 0xb23e39a8, 0x3aa7b61f
.long 0x3b64bc00, 0x361fb9a8, 0xb61f0000, 0xbb6439a8, 0x323e8000, 0x3872b61f, 0x3aa7b9a8, 0x3bd9bb64
.long 0xbc003c00, 0xbc003c00, 0xbc003c00, 0xbc003c00, 0x323e0000, 0x3872b61f, 0x3aa7b9a8, 0x3bd9bb64
.long 0x3b64bc00, 0x361fb9a8, 0xb61f8000, 0xbb6439a8, 0xb8728000, 0xbbd93b64, 0xb23e39a8, 0x3aa7b61f
.long 0xb9a83c00, 0x39a80000, 0x39a8bc00, 0xb9a88000, 0x3aa70000, 0x323ebb64, 0xbbd939a8, 0x3872361f
.long 0x361fbc00, 0xbb6439a8, 0x3b640000, 0xb61fb9a8, 0xbbd98000, 0x3aa7361f, 0xb872b9a8, 0x323e3b64
.long 0x80003c00, 0x0000bc00, 0x80003c00, 0x0000bc00, 0x3bd90000, 0xbaa7361f, 0x3872b9a8, 0xb23e3b64
.long 0xb61fbc00, 0x3b6439a8, 0xbb648000, 0x361fb9a8, 0xbaa78000, 0xb23ebb64, 0x3bd939a8, 0xb872361f
.long 0x39a83c00, 0xb9a88000, 0xb9a8bc00, 0x39a80000, 0x38720000, 0x3bd93b64, 0x323e39a8, 0xbaa7b61f
.long 0xbb64bc00, 0xb61fb9a8, 0x361f0000, 0x3b6439a8, 0xb23e8000, 0xb872b61f, 0xbaa7b9a8, 0xbbd9bb64
.long 0x3c003c00, 0x3c003c00, 0x3c003c00, 0x3c003c00, 0xbbd9bc00, 0xbaa7bb64, 0xb872b9a8, 0xb23eb61f
.long 0x3b643c00, 0x361f39a8, 0xb61f0000, 0xbb64b9a8, 0xbaa7bc00, 0x323eb61f, 0x3bd939a8, 0x38723b64
.long 0x39a83c00, 0xb9a80000, 0xb9a8bc00, 0x39a88000, 0xb872bc00, 0x3bd9361f, 0xb23e39a8, 0xbaa7bb64
.long 0x361f3c00, 0xbb64b9a8, 0x3b648000, 0xb61f39a8, 0xb23ebc00, 0x38723b64, 0xbaa7b9a8, 0x3bd9361f
.long 0x00003c00, 0x8000bc00, 0x00003c00, 0x8000bc00, 0x323ebc00, 0xb8723b64, 0x3aa7b9a8, 0xbbd9361f
.long 0xb61f3c00, 0x3b64b9a8, 0xbb640000, 0x361f39a8, 0x3872bc00, 0xbbd9361f, 0x323e39a8, 0x3aa7bb64
.long 0xb9a83c00, 0x39a88000, 0x39a8bc00, 0xb9a80000, 0x3aa7bc00, 0xb23eb61f, 0xbbd939a8, 0xb8723b64
.long 0xbb643c00, 0xb61f39a8, 0x361f8000, 0x3b64b9a8, 0x3bd9bc00, 0x3aa7bb64, 0x3872b9a8, 0x323eb61f
.long 0xbc003c00, 0xbc003c00, 0xbc003c00, 0xbc003c00, 0x3bd9bc00, 0x3aa7bb64, 0x3872b9a8, 0x323eb61f
.long 0xbb643c00, 0xb61f39a8, 0x361f0000, 0x3b64b9a8, 0x3aa7bc00, 0xb23eb61f, 0xbbd939a8, 0xb8723b64
.long 0xb9a83c00, 0x39a80000, 0x39a8bc00, 0xb9a88000, 0x3872bc00, 0xbbd9361f, 0x323e39a8, 0x3aa7bb64
.long 0xb61f3c00, 0x3b64b9a8, 0xbb648000, 0x361f39a8, 0x323ebc00, 0xb8723b64, 0x3aa7b9a8, 0xbbd9361f
.long 0x80003c00, 0x0000bc00, 0x80003c00, 0x0000bc00, 0xb23ebc00, 0x38723b64, 0xbaa7b9a8, 0x3bd9361f
.long 0x361f3c00, 0xbb64b9a8, 0x3b640000, 0xb61f39a8, 0xb872bc00, 0x3bd9361f, 0xb23e39a8, 0xbaa7bb64
.long 0x39a83c00, 0xb9a88000, 0xb9a8bc00, 0x39a80000, 0xbaa7bc00, 0x323eb61f, 0x3bd939a8, 0x38723b64
.long 0x3b643c00, 0x361f39a8, 0xb61f8000, 0xbb64b9a8, 0xbbd9bc00, 0xbaa7bb64, 0xb872b9a8, 0xb23eb61f
.long 0x3c003c00, 0x3c003c00, 0x3c003c00, 0x3c003c00, 0x323e8000, 0x3872361f, 0x3aa739a8, 0x3bd93b64
.long 0xbb64bc00, 0xb61fb9a8, 0x361f8000, 0x3b6439a8, 0xb8720000, 0xbbd9bb64, 0xb23eb9a8, 0x3aa7361f
.long 0x39a83c00, 0xb9a80000, 0xb9a8bc00, 0x39a88000, 0x3aa78000, 0x323e3b64, 0xbbd9b9a8, 0x3872b61f
.long 0xb61fbc00, 0x3b6439a8, 0xbb640000, 0x361fb9a8, 0xbbd90000, 0x3aa7b61f, 0xb87239a8, 0x323ebb64
.long 0x00003c00, 0x8000bc00, 0x00003c00, 0x8000bc00, 0x3bd98000, 0xbaa7b61f, 0x387239a8, 0xb23ebb64
.long 0x361fbc00, 0xbb6439a8, 0x3b648000, 0xb61fb9a8, 0xbaa70000, 0xb23e3b64, 0x3bd9b9a8, 0xb872b61f
.long 0xb9a83c00, 0x39a88000, 0x39a8bc00, 0xb9a80000, 0x38728000, 0x3bd9bb64, 0x323eb9a8, 0xbaa7361f
.long 0x3b64bc00, 0x361fb9a8, 0xb61f0000, 0xbb6439a8, 0xb23e0000, 0xb872361f, 0xbaa739a8, 0xbbd93b64
.long 0xbc003c00, 0xbc003c00, 0xbc003c00, 0xbc003c00, 0xb23e8000, 0xb872361f, 0xbaa739a8, 0xbbd93b64
.long 0x3b64bc00, 0x361fb9a8, 0xb61f8000, 0xbb6439a8, 0x38720000, 0x3bd9bb64, 0x323eb9a8, 0xbaa7361f
.long 0xb9a83c00, 0x39a80000, 0x39a8bc00, 0xb9a88000, 0xbaa78000, 0xb23e3b64, 0x3bd9b9a8, 0xb872b61f
.long 0x361fbc00, 0xbb6439a8, 0x3b640000, 0xb61fb9a8, 0x3bd90000, 0xbaa7b61f, 0x387239a8, 0xb23ebb64
.long 0x80003c00, 0x0000bc00, 0x80003c00, 0x0000bc00, 0xbbd98000, 0x3aa7b61f, 0xb87239a8, 0x323ebb64
.long 0xb61fbc00, 0x3b6439a8, 0xbb648000, 0x361fb9a8, 0x3aa70000, 0x323e3b64, 0xbbd9b9a8, 0x3872b61f
.long 0x39a83c00, 0xb9a88000, 0xb9a8bc00, 0x39a80000, 0xb8728000, 0xbbd9bb64, 0xb23eb9a8, 0x3aa7361f
.long 0xbb64bc00, 0xb61fb9a8, 0x361f0000, 0x3b6439a8, 0x323e0000, 0x3872361f, 0x3aa739a8, 0x3bd93b64
.long 0x00000000, 0x00000000, 0x00000000, 0x00000000, 0x323e0000, 0x3872361f, 0x3aa739a8, 0x3bd93b64
.long 0x361f0000, 0x3b6439a8, 0x3b643c00, 0x361f39a8, 0x38720000, 0x3bd93b64, 0x323e39a8, 0xbaa7b61f
.long 0x39a80000, 0x39a83c00, 0xb9a80000, 0xb9a8bc00, 0x3aa70000, 0x323e3b64, 0xbbd9b9a8, 0x3872b61f
.long 0x3b640000, 0xb61f39a8, 0xb61fbc00, 0x3b6439a8, 0x3bd90000, 0xbaa7361f, 0x3872b9a8, 0xb23e3b64
.long 0x3c000000, 0xbc000000, 0x3c000000, 0xbc000000, 0x3bd90000, 0xbaa7b61f, 0x387239a8, 0xb23ebb64
.long 0x3b640000, 0xb61fb9a8, 0xb61f3c00, 0x3b64b9a8, 0x3aa70000, 0x323ebb64, 0xbbd939a8, 0x3872361f
.long 0x39a80000, 0x39a8bc00, 0xb9a80000, 0xb9a83c00, 0x38720000, 0x3bd9bb64, 0x323eb9a8, 0xbaa7361f
.long 0x361f0000, 0x3b64b9a8, 0x3b64bc00, 0x361fb9a8, 0x323e0000, 0x3872b61f, 0x3aa7b9a8, 0x3bd9bb64
.long 0x00000000, 0x00000000, 0x00000000, 0x00000000, 0xb23e0000, 0xb872361f, 0xbaa739a8, 0xbbd93b64
.long 0xb61f0000, 0xbb6439a8, 0xbb643c00, 0xb61f39a8, 0xb8720000, 0xbbd93b64, 0xb23e39a8, 0x3aa7b61f
.long 0xb9a80000, 0xb9a83c00, 0x39a80000, 0x39a8bc00, 0xbaa70000, 0xb23e3b64, 0x3bd9b9a8, 0xb872b61f
.long 0xbb640000, 0x361f39a8, 0x361fbc00, 0xbb6439a8, 0xbbd90000, 0x3aa7361f, 0xb872b9a8, 0x323e3b64
.long 0xbc000000, 0x3c000000, 0xbc000000, 0x3c000000, 0xbbd90000, 0x3aa7b61f, 0xb87239a8, 0x323ebb64
.long 0xbb640000, 0x361fb9a8, 0x361f3c00, 0xbb64b9a8, 0xbaa70000, 0xb23ebb64, 0x3bd939a8, 0xb872361f
.long 0xb9a80000, 0xb9a8bc00, 0x39a80000, 0x39a83c00, 0xb8720000, 0xbbd9bb64, 0xb23eb9a8, 0x3aa7361f
.long 0xb61f0000, 0xbb64b9a8, 0xbb64bc00, 0xb61fb9a8, 0xb23e0000, 0xb872b61f, 0xbaa7b9a8, 0xbbd9bb64
.long 0x00000000, 0x00000000, 0x00000000, 0x00000000, 0x3bd93c00, 0x3aa73b64, 0x387239a8, 0x323e361f
.long 0xb61f0000, 0xbb64b9a8, 0xbb64bc00, 0xb61fb9a8, 0xbaa7bc00, 0x323eb61f, 0x3bd939a8, 0x38723b64
.long 0x39a80000, 0x39a83c00, 0xb9a80000, 0xb9a8bc00, 0x38723c00, 0xbbd9b61f, 0x323eb9a8, 0x3aa73b64
.long 0xbb640000, 0x361fb9a8, 0x361f3c00, 0xbb64b9a8, 0xb23ebc00, 0x38723b64, 0xbaa7b9a8, 0x3bd9361f
.long 0x3c000000, 0xbc000000, 0x3c000000, 0xbc000000, 0xb23e3c00, 0x3872bb64, 0xbaa739a8, 0x3bd9b61f
.long 0xbb640000, 0x361f39a8, 0x361fbc00, 0xbb6439a8, 0x3872bc00, 0xbbd9361f, 0x323e39a8, 0x3aa7bb64
.long 0x39a80000, 0x39a8bc00, 0xb9a80000, 0xb9a83c00, 0xbaa73c00, 0x323e361f, 0x3bd9b9a8, 0x3872bb64
.long 0xb61f0000, 0xbb6439a8, 0xbb643c00, 0xb61f39a8, 0x3bd9bc00, 0x3aa7bb64, 0x3872b9a8, 0x323eb61f
.long 0x00000000, 0x00000000, 0x00000000, 0x00000000, 0xbbd93c00, 0xbaa73b64, 0xb87239a8, 0xb23e361f
.long 0x361f0000, 0x3b64b9a8, 0x3b64bc00, 0x361fb9a8, 0x3aa7bc00, 0xb23eb61f, 0xbbd939a8, 0xb8723b64
.long 0xb9a80000, 0xb9a83c00, 0x39a80000, 0x39a8bc00, 0xb8723c00, 0x3bd9b61f, 0xb23eb9a8, 0xbaa73b64
.long 0x3b640000, 0xb61fb9a8, 0xb61f3c00, 0x3b64b9a8, 0x323ebc00, 0xb8723b64, 0x3aa7b9a8, 0xbbd9361f
.long 0xbc000000, 0x3c000000, 0xbc000000, 0x3c000000, 0x323e3c00, 0xb872bb64, 0x3aa739a8, 0xbbd9b61f
.long 0x3b640000, 0xb61f39a8, 0xb61fbc00, 0x3b6439a8, 0xb872bc00, 0x3bd9361f, 0xb23e39a8, 0xbaa7bb64
.long 0xb9a80000, 0xb9a8bc00, 0x39a80000, 0x39a83c00, 0x3aa73c00, 0xb23e361f, 0xbbd9b9a8, 0xb872bb64
.long 0x361f0000, 0x3b6439a8, 0x3b643c00, 0x361f39a8, 0xbbd9bc00, 0xbaa7bb64, 0xb872b9a8, 0xb23eb61f
.long 0x00000000, 0x00000000, 0x00000000, 0x00000000, 0xb23e0000, 0xb872b61f, 0xbaa7b9a8, 0xbbd9bb64
.long 0x361f0000, 0x3b6439a8, 0x3b643c00, 0x361f39a8, 0xb8720000, 0xbbd9bb64, 0xb23eb9a8, 0x3aa7361f
.long 0x39a80000, 0x39a83c00, 0xb9a80000, 0xb9a8bc00, 0xbaa70000, 0xb23ebb64, 0x3bd939a8, 0xb872361f
.long 0x3b640000, 0xb61f39a8, 0xb61fbc00, 0x3b6439a8, 0xbbd90000, 0x3aa7b61f, 0xb87239a8, 0x323ebb64
.long 0x3c000000, 0xbc000000, 0x3c000000, 0xbc000000, 0xbbd90000, 0x3aa7361f, 0xb872b9a8, 0x323e3b64
.long 0x3b640000, 0xb61fb9a8, 0xb61f3c00, 0x3b64b9a8, 0xbaa70000, 0xb23e3b64, 0x3bd9b9a8, 0xb872b61f
.long 0x39a80000, 0x39a8bc00, 0xb9a80000, 0xb9a83c00, 0xb8720000, 0xbbd93b64, 0xb23e39a8, 0x3aa7b61f
.long 0x361f0000, 0x3b64b9a8, 0x3b64bc00, 0x361fb9a8, 0xb23e0000, 0xb872361f, 0xbaa739a8, 0xbbd93b64
.long 0x00000000, 0x00000000, 0x00000000, 0x00000000, 0x323e0000, 0x3872b61f, 0x3aa7b9a8, 0x3bd9bb64
.long 0xb61f0000, 0xbb6439a8, 0xbb643c00, 0xb61f39a8, 0x38720000, 0x3bd9bb64, 0x323eb9a8, 0xbaa7361f
.long 0xb9a80000, 0xb9a83c00, 0x39a80000, 0x39a8bc00, 0x3aa70000, 0x323ebb64, 0xbbd939a8, 0x3872361f
.long 0xbb640000, 0x361f39a8, 0x361fbc00, 0xbb6439a8, 0x3bd90000, 0xbaa7b61f, 0x387239a8, 0xb23ebb64
.long 0xbc000000, 0x3c000000, 0xbc000000, 0x3c000000, 0x3bd90000, 0xbaa7361f, 0x3872b9a8, 0xb23e3b64
.long 0xbb640000, 0x361fb9a8, 0x361f3c00, 0xbb64b9a8, 0x3aa70000, 0x323e3b64, 0xbbd9b9a8, 0x3872b61f
.long 0xb9a80000, 0xb9a8bc00, 0x39a80000, 0x39a83c00, 0x38720000, 0x3bd93b64, 0x323e39a8, 0xbaa7b61f
.long 0xb61f0000, 0xbb64b9a8, 0xbb64bc00, 0xb61fb9a8, 0x323e0000, 0x3872361f, 0x3aa739a8, 0x3bd93b64
.long 0x00000000, 0x00000000, 0x00000000, 0x00000000, 0xbbd9bc00, 0xbaa7bb64, 0xb872b9a8, 0xb23eb61f
.long 0xb61f0000, 0xbb64b9a8, 0xbb64bc00, 0xb61fb9a8, 0x3aa73c00, 0xb23e361f, 0xbbd9b9a8, 0xb872bb64
.long 0x39a80000, 0x39a83c00, 0xb9a80000, 0xb9a8bc00, 0xb872bc00, 0x3bd9361f, 0xb23e39a8, 0xbaa7bb64
.long 0xbb640000, 0x361fb9a8, 0x361f3c00, 0xbb64b9a8, 0x323e3c00, 0xb872bb64, 0x3aa739a8, 0xbbd9b61f
.long 0x3c000000, 0xbc000000, 0x3c000000, 0xbc000000, 0x323ebc00, 0xb8723b64, 0x3aa7b9a8, 0xbbd9361f
.long 0xbb640000, 0x361f39a8, 0x361fbc00, 0xbb6439a8, 0xb8723c00, 0x3bd9b61f, 0xb23eb9a8, 0xbaa73b64
.long 0x39a80000, 0x39a8bc00, 0xb9a80000, 0xb9a83c00, 0x3aa7bc00, 0xb23eb61f, 0xbbd939a8, 0xb8723b64
.long 0xb61f0000, 0xbb6439a8, 0xbb643c00, 0xb61f39a8, 0xbbd93c00, 0xbaa73b64, 0xb87239a8, 0xb23e361f
.long 0x00000000, 0x00000000, 0x00000000, 0x00000000, 0x3bd9bc00, 0x3aa7bb64, 0x3872b9a8, 0x323eb61f
.long 0x361f0000, 0x3b64b9a8, 0x3b64bc00, 0x361fb9a8, 0xbaa73c00, 0x323e361f, 0x3bd9b9a8, 0x3872bb64
.long 0xb9a80000, 0xb9a83c00, 0x39a80000, 0x39a8bc00, 0x3872bc00, 0xbbd9361f, 0x323e39a8, 0x3aa7bb64
.long 0x3b640000, 0xb61fb9a8, 0xb61f3c00, 0x3b64b9a8, 0xb23e3c00, 0x3872bb64, 0xbaa739a8, 0x3bd9b61f
.long 0xbc000000, 0x3c000000, 0xbc000000, 0x3c000000, 0xb23ebc00, 0x38723b64, 0xbaa7b9a8, 0x3bd9361f
.long 0x3b640000, 0xb61f39a8, 0xb61fbc00, 0x3b6439a8, 0x38723c00, 0xbbd9b61f, 0x323eb9a8, 0x3aa73b64
.long 0xb9a80000, 0xb9a8bc00, 0x39a80000, 0x39a83c00, 0xbaa7bc00, 0x323eb61f, 0x3bd939a8, 0x38723b64
.long 0x361f0000, 0x3b6439a8, 0x3b643c00, 0x361f39a8, 0x3bd93c00, 0x3aa73b64, 0x387239a8, 0x323e361f
.long 0x80008000, 0x80008000, 0x80008000, 0x80008000, 0xb23e8000, 0xb872b61f, 0xbaa7b9a8, 0xbbd9bb64
.long 0xb61f8000, 0xbb64b9a8, 0xbb64bc00, 0xb61fb9a8, 0xb8728000, 0xbbd9bb64, 0xb23eb9a8, 0x3aa7361f
.long 0xb9a88000, 0xb9a8bc00, 0x39a88000, 0x39a83c00, 0xbaa78000, 0xb23ebb64, 0x3bd939a8, 0xb872361f
.long 0xbb648000, 0x361fb9a8, 0x361f3c00, 0xbb64b9a8, 0xbbd98000, 0x3aa7b61f, 0xb87239a8, 0x323ebb64
.long 0xbc008000, 0x3c008000, 0xbc008000, 0x3c008000, 0xbbd98000, 0x3aa7361f, 0xb872b9a8, 0x323e3b64
.long 0xbb648000, 0x361f39a8, 0x361fbc00, 0xbb6439a8, 0xbaa78000, 0xb23e3b64, 0x3bd9b9a8, 0xb872b61f
.long 0xb9a88000, 0xb9a83c00, 0x39a88000, 0x39a8bc00, 0xb8728000, 0xbbd93b64, 0xb23e39a8, 0x3aa7b61f
.long 0xb61f8000, 0xbb6439a8, 0xbb643c00, 0xb61f39a8, 0xb23e8000, 0xb872361f, 0xbaa739a8, 0xbbd93b64
.long 0x80008000, 0x80008000, 0x80008000, 0x80008000, 0x323e8000, 0x3872b61f, 0x3aa7b9a8, 0x3bd9bb64
.long 0x361f8000, 0x3b64b9a8, 0x3b64bc00, 0x361fb9a8, 0x38728000, 0x3bd9bb64, 0x323eb9a8, 0xbaa7361f
.long 0x39a88000, 0x39a8bc00, 0xb9a88000, 0xb9a83c00, 0x3aa78000, 0x323ebb64, 0xbbd939a8, 0x3872361f
.long 0x3b648000, 0xb61fb9a8, 0xb61f3c00, 0x3b64b9a8, 0x3bd98000, 0xbaa7b61f, 0x387239a8, 0xb23ebb64
.long 0x3c008000, 0xbc008000, 0x3c008000, 0xbc008000, 0x3bd98000, 0xbaa7361f, 0x3872b9a8, 0xb23e3b64
.long 0x3b648000, 0xb61f39a8, 0xb61fbc00, 0x3b6439a8, 0x3aa78000, 0x323e3b64, 0xbbd9b9a8, 0x3872b61f
.long 0x39a88000, 0x39a83c00, 0xb9a88000, 0xb9a8bc00, 0x38728000, 0x3bd93b64, 0x323e39a8, 0xbaa7b61f
.long 0x361f8000, 0x3b6439a8, 0x3b643c00, 0x361f39a8, 0x323e8000, 0x3872361f, 0x3aa739a8, 0x3bd93b64
.long 0x80008000, 0x80008000, 0x80008000, 0x80008000, 0xbbd9bc00, 0xbaa7bb64, 0xb872b9a8, 0xb23eb61f
.long 0x361f8000, 0x3b6439a8, 0x3b643c00, 0x361f39a8, 0x3aa73c00, 0xb23e361f, 0xbbd9b9a8, 0xb872bb64
.long 0xb9a88000, 0xb9a8bc00, 0x39a88000, 0x39a83c00, 0xb872bc00, 0x3bd9361f, 0xb23e39a8, 0xbaa7bb64
.long 0x3b648000, 0xb61f39a8, 0xb61fbc00, 0x3b6439a8, 0x323e3c00, 0xb872bb64, 0x3aa739a8, 0xbbd9b61f
.long 0xbc008000, 0x3c008000, 0xbc008000, 0x3c008000, 0x323ebc00, 0xb8723b64, 0x3aa7b9a8, 0xbbd9361f
.long 0x3b648000, 0xb61fb9a8, 0xb61f3c00, 0x3b64b9a8, 0xb8723c00, 0x3bd9b61f, 0xb23eb9a8, 0xbaa73b64
.long 0xb9a88000, 0xb9a83c00, 0x39a88000, 0x39a8bc00, 0x3aa7bc00, 0xb23eb61f, 0xbbd939a8, 0xb8723b64
.long 0x361f8000, 0x3b64b9a8, 0x3b64bc00, 0x361fb9a8, 0xbbd93c00, 0xbaa73b64, 0xb87239a8, 0xb23e361f
.long 0x80008000, 0x80008000, 0x80008000, 0x80008000, 0x3bd9bc00, 0x3aa7bb64, 0x3872b9a8, 0x323eb61f
.long 0xb61f8000, 0xbb6439a8, 0xbb643c00, 0xb61f39a8, 0xbaa73c00, 0x323e361f, 0x3bd9b9a8, 0x3872bb64
.long 0x39a88000, 0x39a8bc00, 0xb9a88000, 0xb9a83c00, 0x3872bc00, 0xbbd9361f, 0x323e39a8, 0x3aa7bb64
.long 0xbb648000, 0x361f39a8, 0x361fbc00, 0xbb6439a8, 0xb23e3c00, 0x3872bb64, 0xbaa739a8, 0x3bd9b61f
.long 0x3c008000, 0xbc008000, 0x3c008000, 0xbc008000, 0xb23ebc00, 0x38723b64, 0xbaa7b9a8, 0x3bd9361f
.long 0xbb648000, 0x361fb9a8, 0x361f3c00, 0xbb64b9a8, 0x38723c00, 0xbbd9b61f, 0x323eb9a8, 0x3aa73b64
.long 0x39a88000, 0x39a83c00, 0xb9a88000, 0xb9a8bc00, 0xbaa7bc00, 0x323eb61f, 0x3bd939a8, 0x38723b64
.long 0xb61f8000, 0xbb64b9a8, 0xbb64bc00, 0xb61fb9a8, 0x3bd93c00, 0x3aa73b64, 0x387239a8, 0x323e361f
.long 0x80008000, 0x80008000, 0x80008000, 0x80008000, 0x323e8000, 0x3872361f, 0x3aa739a8, 0x3bd93b64
.long 0xb61f8000, 0xbb64b9a8, 0xbb64bc00, 0xb61fb9a8, 0x38728000, 0x3bd93b64, 0x323e39a8, 0xbaa7b61f
.long 0xb9a88000, 0xb9a8bc00, 0x39a88000, 0x39a83c00, 0x3aa78000, 0x323e3b64, 0xbbd9b9a8, 0x3872b61f
.long 0xbb648000, 0x361fb9a8, 0x361f3c00, 0xbb64b9a8, 0x3bd98000, 0xbaa7361f, 0x3872b9a8, 0xb23e3b64
.long 0xbc008000, 0x3c008000, 0xbc008000, 0x3c008000, 0x3bd98000, 0xbaa7b61f, 0x387239a8, 0xb23ebb64
.long 0xbb648000, 0x361f39a8, 0x361fbc00, 0xbb6439a8, 0x3aa78000, 0x323ebb64, 0xbbd939a8, 0x3872361f
.long 0xb9a88000, 0xb9a83c00, 0x39a88000, 0x39a8bc00, 0x38728000, 0x3bd9bb64, 0x323eb9a8, 0xbaa7361f
.long 0xb61f8000, 0xbb6439a8, 0xbb643c00, 0xb61f39a8, 0x323e8000, 0x3872b61f, 0x3aa7b9a8, 0x3bd9bb64
.long 0x80008000, 0x80008000, 0x80008000, 0x80008000, 0xb23e8000, 0xb872361f, 0xbaa739a8, 0xbbd93b64
.long 0x361f8000, 0x3b64b9a8, 0x3b64bc00, 0x361fb9a8, 0xb8728000, 0xbbd93b64, 0xb23e39a8, 0x3aa7b61f
.long 0x39a88000, 0x39a8bc00, 0xb9a88000, 0xb9a83c00, 0xbaa78000, 0xb23e3b64, 0x3bd9b9a8, 0xb872b61f
.long 0x3b648000, 0xb61fb9a8, 0xb61f3c00, 0x3b64b9a8, 0xbbd98000, 0x3aa7361f, 0xb872b9a8, 0x323e3b64
.long 0x3c008000, 0xbc008000, 0x3c008000, 0xbc008000, 0xbbd98000, 0x3aa7b61f, 0xb87239a8, 0x323ebb64
.long 0x3b648000, 0xb61f39a8, 0xb61fbc00, 0x3b6439a8, 0xbaa78000, 0xb23ebb64, 0x3bd939a8, 0xb872361f
.long 0x39a88000, 0x39a83c00, 0xb9a88000, 0xb9a8bc00, 0xb8728000, 0xbbd9bb64, 0xb23eb9a8, 0x3aa7361f
.long 0x361f8000, 0x3b6439a8, 0x3b643c00, 0x361f39a8, 0xb23e8000, 0xb872b61f, 0xbaa7b9a8, 0xbbd9bb64
.long 0x80008000, 0x80008000, 0x80008000, 0x80008000, 0x3bd93c00, 0x3aa73b64, 0x387239a8, 0x323e361f
.long 0x361f8000, 0x3b6439a8, 0x3b643c00, 0x361f39a8, 0xbaa7bc00, 0x323eb61f, 0x3bd939a8, 0x38723b64
.long 0xb9a88000, 0xb9a8bc00, 0x39a88000, 0x39a83c00, 0x38723c00, 0xbbd9b61f, 0x323eb9a8, 0x3aa73b64
.long 0x3b648000, 0xb61f39a8, 0xb61fbc00, 0x3b6439a8, 0xb23ebc00, 0x38723b64, 0xbaa7b9a8, 0x3bd9361f
.long 0xbc008000, 0x3c008000, 0xbc008000, 0x3c008000, 0xb23e3c00, 0x3872bb64, 0xbaa739a8, 0x3bd9b61f
.long 0x3b648000, 0xb61fb9a8, 0xb61f3c00, 0x3b64b9a8, 0x3872bc00, 0xbbd9361f, 0x323e39a8, 0x3aa7bb64
.long 0xb9a88000, 0xb9a83c00, 0x39a88000, 0x39a8bc00, 0xbaa73c00, 0x323e361f, 0x3bd9b9a8, 0x3872bb64
.long 0x361f8000, 0x3b64b9a8, 0x3b64bc00, 0x361fb9a8, 0x3bd9bc00, 0x3aa7bb64, 0x3872b9a8, 0x323eb61f
.long 0x80008000, 0x80008000, 0x80008000, 0x80008000, 0xbbd93c00, 0xbaa73b64, 0xb87239a8, 0xb23e361f
.long 0xb61f8000, 0xbb6439a8, 0xbb643c00, 0xb61f39a8, 0x3aa7bc00, 0xb23eb61f, 0xbbd939a8, 0xb8723b64
.long 0x39a88000, 0x39a8bc00, 0xb9a88000, 0xb9a83c00, 0xb8723c00, 0x3bd9b61f, 0xb23eb9a8, 0xbaa73b64
.long 0xbb648000, 0x361f39a8, 0x361fbc00, 0xbb6439a8, 0x323ebc00, 0xb8723b64, 0x3aa7b9a8, 0xbbd9361f
.long 0x3c008000, 0xbc008000, 0x3c008000, 0xbc008000, 0x323e3c00, 0xb872bb64, 0x3aa739a8, 0xbbd9b61f
.long 0xbb648000, 0x361fb9a8, 0x361f3c00, 0xbb64b9a8, 0xb872bc00, 0x3bd9361f, 0xb23e39a8, 0xbaa7bb64
.long 0x39a88000, 0x39a83c00, 0xb9a88000, 0xb9a8bc00, 0x3aa73c00, 0xb23e361f, 0xbbd9b9a8, 0xb872bb64
.long 0xb61f8000, 0xbb64b9a8, 0xbb64bc00, 0xb61fb9a8, 0xbbd9bc00, 0xbaa7bb64, 0xb872b9a8, 0xb23eb61f
.long 0x3f800000, 0x3f800000, 0x3f800000, 0x3f800000, 0x3f800000, 0x3f7ffcd7, 0x3f7ff35e, 0x3f7fe394
.long 0x3f800000, 0x3f7ff35e, 0x3f7fcd79, 0x3f7f8e56, 0x3f800000, 0x3f7fe394, 0x3f7f8e56, 0x3f7f0059
.long 0x3f800000, 0x3f7fcd79, 0x3f7f35f9, 0x3f7e39bc, 0x3f800000, 0x3f7fb10f, 0x3f7ec46d, 0x3f7d3aac
.long 0x3f800000, 0x3f7f8e56, 0x3f7e39bc, 0x3f7c0361, 0x3f800000, 0x3f7f654e, 0x3f7d95f4, 0x3f7a9421
.long 0x3f800000, 0x3f7f35f9, 0x3f7cd925, 0x3f78ed3c, 0x3f800000, 0x3f7f0059, 0x3f7c0361, 0x3f770f11
.long 0x3f800000, 0x3f7ec46d, 0x3f7b14be, 0x3f74fa0b, 0x3f800000, 0x3f7e8238, 0x3f7a0d54, 0x3f72ae9e
.long 0x3f800000, 0x3f7e39bc, 0x3f78ed3c, 0x3f702d4f, 0x3f800000, 0x3f7deafa, 0x3f77b493, 0x3f6d76aa
.long 0x3f800000, 0x3f7d95f4, 0x3f766377, 0x3f6a8b4b, 0x3f800000, 0x3f7d3aac, 0x3f74fa0b, 0x3f676bd8
.long 0x3f800000, 0x3f7cd925, 0x3f737871, 0x3f641901, 0x3f800000, 0x3f7c7160, 0x3f71decf, 0x3f609384
.long 0x3f800000, 0x3f7c0361, 0x3f702d4f, 0x3f5cdc29, 0x3f800000, 0x3f7b8f2a, 0x3f6e641a, 0x3f58f3c4
.long 0x3f800000, 0x3f7b14be, 0x3f6c835e, 0x3f54db31, 0x3f800000, 0x3f7a9421, 0x3f6a8b4b, 0x3f50935b
.long 0x3f800000, 0x3f7a0d54, 0x3f687c12, 0x3f4c1d35, 0x3f800000, 0x3f79805c, 0x3f6655e7, 0x3f4779bc
.long 0x3f800000, 0x3f78ed3c, 0x3f641901, 0x3f42a9f7, 0x3f800000, 0x3f7853f8, 0x3f61c598, 0x3f3daef9
.long 0x3f800000, 0x3f77b493, 0x3f5f5be6, 0x3f3889dc, 0x3f800000, 0x3f770f11, 0x3f5cdc29, 0x3f333bc6
.long 0x3f800000, 0x3f766377, 0x3f5a46a0, 0x3f2dc5e3, 0x3f800000, 0x3f75b1c9, 0x3f579b8c, 0x3f28296a
.long 0x3f800000, 0x3f74fa0b, 0x3f54db31, 0x3f226799, 0x3f800000, 0x3f743c41, 0x3f5205d4, 0x3f1c81b9
.long 0x3f800000, 0x3f800000, 0x3f800000, 0x3f800000, 0x3f7fcd79, 0x3f7fb10f, 0x3f7f8e56, 0x3f7f654e
.long 0x3f7f35f9, 0x3f7ec46d, 0x3f7e39bc, 0x3f7d95f4, 0x3f7e39bc, 0x3f7d3aac, 0x3f7c0361, 0x3f7a9421
.long 0x3f7cd925, 0x3f7b14be, 0x3f78ed3c, 0x3f766377, 0x3f7b14be, 0x3f7853f8, 0x3f74fa0b, 0x3f710908
.long 0x3f78ed3c, 0x3f74fa0b, 0x3f702d4f, 0x3f6a8b4b, 0x3f766377, 0x3f710908, 0x3f6a8b4b, 0x3f62f219
.long 0x3f737871, 0x3f6c835e, 0x3f641901, 0x3f5a46a0, 0x3f702d4f, 0x3f676bd8, 0x3f5cdc29, 0x3f50935b
.long 0x3f6c835e, 0x3f61c598, 0x3f54db31, 0x3f45e403, 0x3f687c12, 0x3f5b941a, 0x3f4c1d35, 0x3f3a4582
.long 0x3f641901, 0x3f54db31, 0x3f42a9f7, 0x3f2dc5e3, 0x3f5f5be6, 0x3f4d9f02, 0x3f3889dc, 0x3f207440
.long 0x3f5a46a0, 0x3f45e403, 0x3f2dc5e3, 0x3f1260b2, 0x3f54db31, 0x3f3daef9, 0x3f226799, 0x3f039c3d
.long 0x3f4f1bbd, 0x3f3504f3, 0x3f167918, 0x3ee87171, 0x3f490a88, 0x3f2beb4a, 0x3f0a04f8, 0x3ec8917e
.long 0x3f42a9f7, 0x3f226799, 0x3efa2c90, 0x3ea7bf25, 0x3f3bfc8f, 0x3f187fc0, 0x3edf7108, 0x3e862210
.long 0x3f3504f3, 0x3f0e39da, 0x3ec3ef15, 0x3e47c5c2, 0x3f2dc5e3, 0x3f039c3d, 0x3ea7bf25, 0x3e0255f4
.long 0x3f26423a, 0x3ef15aea, 0x3e8afa3e, 0x3d712283, 0x3f1e7cf1, 0x3edae880, 0x3e5b73dc, 0xbc20d8d2
.long 0x3f167918, 0x3ec3ef15, 0x3e20305b, 0xbda0af2a, 0x3f0e39da, 0x3eac7cd4, 0x3dc8bd36, 0xbe164083
.long 0x3f05c277, 0x3e94a031, 0x3d20cee7, 0xbe5b73dc, 0x3efa2c90, 0x3e78cfcc, 0xbca0d6d6, 0xbe8fcefe
.long 0x3ee87171, 0x3e47c5c2, 0xbda0af2a, 0xbeb13641, 0x3ed65a92, 0x3e164083, 0xbe0c4cf7, 0xbed1c759
.long 0x3ec3ef15, 0x3dc8bd36, 0xbe47c5c2, 0xbef15aea, 0x3eb13641, 0x3d48fb30, 0xbe814693, 0xbf07e565
.long 0x3f800000, 0x3f800000, 0x3f800000, 0x3f800000, 0x3f7f35f9, 0x3f7f0059, 0x3f7ec46d, 0x3f7e8238
.long 0x3f7cd925, 0x3f7c0361, 0x3f7b14be, 0x3f7a0d54, 0x3f78ed3c, 0x3f770f11, 0x3f74fa0b, 0x3f72ae9e
.long 0x3f737871, 0x3f702d4f, 0x3f6c835e, 0x3f687c12, 0x3f6c835e, 0x3f676bd8, 0x3f61c598, 0x3f5b941a
.long 0x3f641901, 0x3f5cdc29, 0x3f54db31, 0x3f4c1d35, 0x3f5a46a0, 0x3f50935b, 0x3f45e403, 0x3f3a4582
.long 0x3f4f1bbd, 0x3f42a9f7, 0x3f3504f3, 0x3f26423a, 0x3f42a9f7, 0x3f333bc6, 0x3f226799, 0x3f104f0e
.long 0x3f3504f3, 0x3f226799, 0x3f0e39da, 0x3ef15aea, 0x3f26423a, 0x3f104f0e, 0x3ef15aea, 0x3ebf47d7
.long 0x3f167918, 0x3efa2c90, 0x3ec3ef15, 0x3e8afa3e, 0x3f05c277, 0x3ed1c759, 0x3e94a031, 0x3e2a1c3f
.long 0x3ee87171, 0x3ea7bf25, 0x3e47c5c2, 0x3d712283, 0x3ec3ef15, 0x3e78cfcc, 0x3dc8bd36, 0xbd48fb30
.long 0x3e9e377a, 0x3e20305b, 0x248d3132, 0xbe20305b, 0x3e6f0c4d, 0x3d8ca1f2, 0xbdc8bd36, 0xbe862210
.long 0x3e20305b, 0xbca0d6d6, 0xbe47c5c2, 0xbeba9be1, 0x3da0af2a, 0xbddcbd0d, 0xbe94a031, 0xbeece91a
.long 0x248d3132, 0xbe47c5c2, 0xbec3ef15, 0xbf0e39da, 0xbda0af2a, 0xbe8fcefe, 0xbef15aea, 0xbf2456f1
.long 0xbe20305b, 0xbeba9be1, 0xbf0e39da, 0xbf3889dc, 0xbe6f0c4d, 0xbee3f40d, 0xbf226799, 0xbf4a965e
.long 0xbe9e377a, 0xbf05c277, 0xbf3504f3, 0xbf5a46a0, 0xbec3ef15, 0xbf187fc0, 0xbf45e403, 0xbf676bd8
.long 0xbee87171, 0xbf2a0c73, 0xbf54db31, 0xbf71decf, 0xbf05c277, 0xbf3a4582, 0xbf61c598, 0xbf79805c
.long 0xbf167918, 0xbf490a88, 0xbf6c835e, 0xbf7e39bc, 0xbf26423a, 0xbf563e03, 0xbf74fa0b, 0xbf7ffcd7
.long 0xbf3504f3, 0xbf61c598, 0xbf7b14be, 0xbf7ec46d, 0xbf42a9f7, 0xbf6b8a3d, 0xbf7ec46d, 0xbf7a9421
.long 0x3f800000, 0x3f800000, 0x3f800000, 0x3f800000, 0x3f7e39bc, 0x3f7deafa, 0x3f7d95f4, 0x3f7d3aac
.long 0x3f78ed3c, 0x3f77b493, 0x3f766377, 0x3f74fa0b, 0x3f702d4f, 0x3f6d76aa, 0x3f6a8b4b, 0x3f676bd8
.long 0x3f641901, 0x3f5f5be6, 0x3f5a46a0, 0x3f54db31, 0x3f54db31, 0x3f4d9f02, 0x3f45e403, 0x3f3daef9
.long 0x3f42a9f7, 0x3f3889dc, 0x3f2dc5e3, 0x3f226799, 0x3f2dc5e3, 0x3f207440, 0x3f1260b2, 0x3f039c3d
.long 0x3f167918, 0x3f05c277, 0x3ee87171, 0x3ec3ef15, 0x3efa2c90, 0x3ed1c759, 0x3ea7bf25, 0x3e78cfcc
.long 0x3ec3ef15, 0x3e94a031, 0x3e47c5c2, 0x3dc8bd36, 0x3e8afa3e, 0x3e2a1c3f, 0x3d712283, 0xbd48fb30
.long 0x3e20305b, 0x3d20cee7, 0xbda0af2a, 0xbe47c5c2, 0x3d20cee7, 0xbdb4b86a, 0xbe5b73dc, 0xbeac7cd4
.long 0xbda0af2a, 0xbe5b73dc, 0xbeb13641, 0xbef15aea, 0xbe47c5c2, 0xbeac7cd4, 0xbef15aea, 0xbf187fc0
.long 0xbe9e377a, 0xbee87171, 0xbf167918, 0xbf3504f3, 0xbed65a92, 0xbf104f0e, 0xbf316e2c, 0xbf4d9f02
.long 0xbf05c277, 0xbf2a0c73, 0xbf490a88, 0xbf61c598, 0xbf1e7cf1, 0xbf4105b8, 0xbf5cdc29, 0xbf710908
.long 0xbf3504f3, 0xbf54db31, 0xbf6c835e, 0xbf7b14be, 0xbf490a88, 0xbf653a48, 0xbf77b493, 0xbf7fb10f
.long 0xbf5a46a0, 0xbf71decf, 0xbf7e39bc, 0xbf7ec46d, 0xbf687c12, 0xbf7a9421, 0xbf7ff35e, 0xbf7853f8
.long 0xbf737871, 0xbf7f35f9, 0xbf7cd925, 0xbf6c835e, 0xbf7b14be, 0xbf7fb10f, 0xbf74fa0b, 0xbf5b941a
.long 0xbf7f35f9, 0xbf7c0361, 0xbf687c12, 0xbf45e403, 0xbf7fcd79, 0xbf743c41, 0xbf579b8c, 0xbf2beb4a
.long 0xbf7cd925, 0xbf687c12, 0xbf42a9f7, 0xbf0e39da, 0xbf766377, 0xbf58f3c4, 0xbf2a0c73, 0xbedae880
.long 0xbf6c835e, 0xbf45e403, 0xbf0e39da, 0xbe94a031, 0xbf5f5be6, 0xbf2f9c32, 0xbedf7108, 0xbe164083
.long 0x3f800000, 0x3f800000, 0x3f800000, 0x3f800000, 0x3f7cd925, 0x3f7c7160, 0x3f7c0361, 0x3f7b8f2a
.long 0x3f737871, 0x3f71decf, 0x3f702d4f, 0x3f6e641a, 0x3f641901, 0x3f609384, 0x3f5cdc29, 0x3f58f3c4
.long 0x3f4f1bbd, 0x3f490a88, 0x3f42a9f7, 0x3f3bfc8f, 0x3f3504f3, 0x3f2beb4a, 0x3f226799, 0x3f187fc0
.long 0x3f167918, 0x3f0a04f8, 0x3efa2c90, 0x3edf7108, 0x3ee87171, 0x3ec8917e, 0x3ea7bf25, 0x3e862210
.long 0x3e9e377a, 0x3e6f0c4d, 0x3e20305b, 0x3da0af2a, 0x3e20305b, 0x3d8ca1f2, 0xbca0d6d6, 0xbddcbd0d
.long 0x248d3132, 0xbdc8bd36, 0xbe47c5c2, 0xbe94a031, 0xbe20305b, 0xbe862210, 0xbeba9be1, 0xbeece91a
.long 0xbe9e377a, 0xbed65a92, 0xbf05c277, 0xbf1e7cf1, 0xbee87171, 0xbf104f0e, 0xbf2a0c73, 0xbf4105b8
.long 0xbf167918, 0xbf316e2c, 0xbf490a88, 0xbf5cdc29, 0xbf3504f3, 0xbf4d9f02, 0xbf61c598, 0xbf710908
.long 0xbf4f1bbd, 0xbf641901, 0xbf737871, 0xbf7cd925, 0xbf641901, 0xbf743c41, 0xbf7d95f4, 0xbf7fe394
.long 0xbf737871, 0xbf7d95f4, 0xbf7fcd79, 0xbf7a0d54, 0xbf7cd925, 0xbf7fe394, 0xbf7a0d54, 0xbf6b8a3d
.long 0xbf800000, 0xbf7b14be, 0xbf6c835e, 0xbf54db31, 0xbf7cd925, 0xbf6f4ba8, 0xbf579b8c, 0xbf36c9a9
.long 0xbf737871, 0xbf5cdc29, 0xbf3bfc8f, 0xbf1260b2, 0xbf641901, 0xbf444969, 0xbf1a82a4, 0xbed1c759
.long 0xbf4f1bbd, 0xbf26423a, 0xbee87171, 0xbe6f0c4d, 0xbf3504f3, 0xbf039c3d, 0xbe94a031, 0xbd48fb30
.long 0xbf167918, 0xbeba9be1, 0xbdf0b772, 0x3e0c4cf7, 0xbee87171, 0xbe519f65, 0x3d712283, 0x3ea2fd52
.long 0xbe9e377a, 0xbd20cee7, 0x3e6f0c4d, 0x3efa2c90, 0xbe20305b, 0x3e0255f4, 0x3ecd2ef3, 0x3f2456f1
.long 0xa553c9ca, 0x3e94a031, 0x3f0e39da, 0x3f45e403, 0x3e20305b, 0x3ee3f40d, 0x3f316e2c, 0x3f609384
.long 0x00000000, 0x00000000, 0x00000000, 0x00000000, 0x00000000, 0x00000000, 0x00000000, 0x00000000
.long 0x00000000, 0x00000000, 0x00000000, 0x00000000, 0x00000000, 0x00000000, 0x00000000, 0x00000000
.long 0x00000000, 0x00000000, 0x00000000, 0x00000000, 0x00000000, 0x00000000, 0x00000000, 0x00000000
.long 0x00000000, 0x00000000, 0x00000000, 0x00000000, 0x00000000, 0x00000000, 0x00000000, 0x00000000
.long 0x00000000, 0x00000000, 0x00000000, 0x00000000, 0x00000000, 0x00000000, 0x00000000, 0x00000000
.long 0x00000000, 0x00000000, 0x00000000, 0x00000000, 0x00000000, 0x00000000, 0x00000000, 0x00000000
.long 0x00000000, 0x00000000, 0x00000000, 0x00000000, 0x00000000, 0x00000000, 0x00000000, 0x00000000
.long 0x00000000, 0x00000000, 0x00000000, 0x00000000, 0x00000000, 0x00000000, 0x00000000, 0x00000000
.long 0x00000000, 0x00000000, 0x00000000, 0x00000000, 0x00000000, 0x00000000, 0x00000000, 0x00000000
.long 0x00000000, 0x00000000, 0x00000000, 0x00000000, 0x00000000, 0x00000000, 0x00000000, 0x00000000
.long 0x00000000, 0x00000000, 0x00000000, 0x00000000, 0x00000000, 0x00000000, 0x00000000, 0x00000000
.long 0x00000000, 0x00000000, 0x00000000, 0x00000000, 0x00000000, 0x00000000, 0x00000000, 0x00000000
.long 0x00000000, 0x00000000, 0x00000000, 0x00000000, 0x00000000, 0x00000000, 0x00000000, 0x00000000
.long 0x00000000, 0x00000000, 0x00000000, 0x00000000, 0x00000000, 0x00000000, 0x00000000, 0x00000000
.long 0x00000000, 0x00000000, 0x00000000, 0x00000000, 0x00000000, 0x00000000, 0x00000000, 0x00000000
.long 0x00000000, 0x00000000, 0x00000000, 0x00000000, 0x00000000, 0x00000000, 0x00000000, 0x00000000
.long 0x00000000, 0x00000000, 0x00000000, 0x00000000, 0x00000000, 0x3c20d8d2, 0x3ca0d6d6, 0x3cf13d4c
.long 0x00000000, 0x3ca0d6d6, 0x3d20cee7, 0x3d712283, 0x00000000, 0x3cf13d4c, 0x3d712283, 0x3db4b86a
.long 0x00000000, 0x3d20cee7, 0x3da0af2a, 0x3df0b772, 0x00000000, 0x3d48fb30, 0x3dc8bd36, 0x3e164083
.long 0x00000000, 0x3d712283, 0x3df0b772, 0x3e3403f1, 0x00000000, 0x3d8ca1f2, 0x3e0c4cf7, 0x3e519f65
.long 0x00000000, 0x3da0af2a, 0x3e20305b, 0x3e6f0c4d, 0x00000000, 0x3db4b86a, 0x3e3403f1, 0x3e862210
.long 0x00000000, 0x3dc8bd36, 0x3e47c5c2, 0x3e94a031, 0x00000000, 0x3ddcbd0d, 0x3e5b73dc, 0x3ea2fd52
.long 0x00000000, 0x3df0b772, 0x3e6f0c4d, 0x3eb13641, 0x00000000, 0x3e0255f4, 0x3e814693, 0x3ebf47d7
.long 0x00000000, 0x3e0c4cf7, 0x3e8afa3e, 0x3ecd2ef3, 0x00000000, 0x3e164083, 0x3e94a031, 0x3edae880
.long 0x00000000, 0x3e20305b, 0x3e9e377a, 0x3ee87171, 0x00000000, 0x3e2a1c3f, 0x3ea7bf25, 0x3ef5c6c5
.long 0x00000000, 0x3e3403f1, 0x3eb13641, 0x3f0172c3, 0x00000000, 0x3e3de731, 0x3eba9be1, 0x3f07e565
.long 0x00000000, 0x3e47c5c2, 0x3ec3ef15, 0x3f0e39da, 0x00000000, 0x3e519f65, 0x3ecd2ef3, 0x3f146eba
.long 0x00000000, 0x3e5b73dc, 0x3ed65a92, 0x3f1a82a4, 0x00000000, 0x3e6542e9, 0x3edf7108, 0x3f207440
.long 0x00000000, 0x3e6f0c4d, 0x3ee87171, 0x3f26423a, 0x00000000, 0x3e78cfcc, 0x3ef15aea, 0x3f2beb4a
.long 0x00000000, 0x3e814693, 0x3efa2c90, 0x3f316e2c, 0x00000000, 0x3e862210, 0x3f0172c3, 0x3f36c9a9
.long 0x00000000, 0x3e8afa3e, 0x3f05c277, 0x3f3bfc8f, 0x00000000, 0x3e8fcefe, 0x3f0a04f8, 0x3f4105b8
.long 0x00000000, 0x3e94a031, 0x3f0e39da, 0x3f45e403, 0x00000000, 0x3e996dba, 0x3f1260b2, 0x3f4a965e
.long 0x00000000, 0x00000000, 0x00000000, 0x00000000, 0x3d20cee7, 0x3d48fb30, 0x3d712283, 0x3d8ca1f2
.long 0x3da0af2a, 0x3dc8bd36, 0x3df0b772, 0x3e0c4cf7, 0x3df0b772, 0x3e164083, 0x3e3403f1, 0x3e519f65
.long 0x3e20305b, 0x3e47c5c2, 0x3e6f0c4d, 0x3e8afa3e, 0x3e47c5c2, 0x3e78cfcc, 0x3e94a031, 0x3eac7cd4
.long 0x3e6f0c4d, 0x3e94a031, 0x3eb13641, 0x3ecd2ef3, 0x3e8afa3e, 0x3eac7cd4, 0x3ecd2ef3, 0x3eece91a
.long 0x3e9e377a, 0x3ec3ef15, 0x3ee87171, 0x3f05c277, 0x3eb13641, 0x3edae880, 0x3f0172c3, 0x3f146eba
.long 0x3ec3ef15, 0x3ef15aea, 0x3f0e39da, 0x3f226799, 0x3ed65a92, 0x3f039c3d, 0x3f1a82a4, 0x3f2f9c32
.long 0x3ee87171, 0x3f0e39da, 0x3f26423a, 0x3f3bfc8f, 0x3efa2c90, 0x3f187fc0, 0x3f316e2c, 0x3f4779bc
.long 0x3f05c277, 0x3f226799, 0x3f3bfc8f, 0x3f5205d4, 0x3f0e39da, 0x3f2beb4a, 0x3f45e403, 0x3f5b941a
.long 0x3f167918, 0x3f3504f3, 0x3f4f1bbd, 0x3f641901, 0x3f1e7cf1, 0x3f3daef9, 0x3f579b8c, 0x3f6b8a3d
.long 0x3f26423a, 0x3f45e403, 0x3f5f5be6, 0x3f71decf, 0x3f2dc5e3, 0x3f4d9f02, 0x3f6655e7, 0x3f770f11
.long 0x3f3504f3, 0x3f54db31, 0x3f6c835e, 0x3f7b14be, 0x3f3bfc8f, 0x3f5b941a, 0x3f71decf, 0x3f7deafa
.long 0x3f42a9f7, 0x3f61c598, 0x3f766377, 0x3f7f8e56, 0x3f490a88, 0x3f676bd8, 0x3f7a0d54, 0x3f7ffcd7
.long 0x3f4f1bbd, 0x3f6c835e, 0x3f7cd925, 0x3f7f35f9, 0x3f54db31, 0x3f710908, 0x3f7ec46d, 0x3f7d3aac
.long 0x3f5a46a0, 0x3f74fa0b, 0x3f7fcd79, 0x3f7a0d54, 0x3f5f5be6, 0x3f7853f8, 0x3f7ff35e, 0x3f75b1c9
.long 0x3f641901, 0x3f7b14be, 0x3f7f35f9, 0x3f702d4f, 0x3f687c12, 0x3f7d3aac, 0x3f7d95f4, 0x3f698690
.long 0x3f6c835e, 0x3f7ec46d, 0x3f7b14be, 0x3f61c598, 0x3f702d4f, 0x3f7fb10f, 0x3f77b493, 0x3f58f3c4
.long 0x00000000, 0x00000000, 0x00000000, 0x00000000, 0x3da0af2a, 0x3db4b86a, 0x3dc8bd36, 0x3ddcbd0d
.long 0x3e20305b, 0x3e3403f1, 0x3e47c5c2, 0x3e5b73dc, 0x3e6f0c4d, 0x3e862210, 0x3e94a031, 0x3ea2fd52
.long 0x3e9e377a, 0x3eb13641, 0x3ec3ef15, 0x3ed65a92, 0x3ec3ef15, 0x3edae880, 0x3ef15aea, 0x3f039c3d
.long 0x3ee87171, 0x3f0172c3, 0x3f0e39da, 0x3f1a82a4, 0x3f05c277, 0x3f146eba, 0x3f226799, 0x3f2f9c32
.long 0x3f167918, 0x3f26423a, 0x3f3504f3, 0x3f42a9f7, 0x3f26423a, 0x3f36c9a9, 0x3f45e403, 0x3f53731f
.long 0x3f3504f3, 0x3f45e403, 0x3f54db31, 0x3f61c598, 0x3f42a9f7, 0x3f53731f, 0x3f61c598, 0x3f6d76aa
.long 0x3f4f1bbd, 0x3f5f5be6, 0x3f6c835e, 0x3f766377, 0x3f5a46a0, 0x3f698690, 0x3f74fa0b, 0x3f7c7160
.long 0x3f641901, 0x3f71decf, 0x3f7b14be, 0x3f7f8e56, 0x3f6c835e, 0x3f7853f8, 0x3f7ec46d, 0x3f7fb10f
.long 0x3f737871, 0x3f7cd925, 0x3f800000, 0x3f7cd925, 0x3f78ed3c, 0x3f7f654e, 0x3f7ec46d, 0x3f770f11
.long 0x3f7cd925, 0x3f7ff35e, 0x3f7b14be, 0x3f6e641a, 0x3f7f35f9, 0x3f7e8238, 0x3f74fa0b, 0x3f62f219
.long 0x3f800000, 0x3f7b14be, 0x3f6c835e, 0x3f54db31, 0x3f7f35f9, 0x3f75b1c9, 0x3f61c598, 0x3f444969
.long 0x3f7cd925, 0x3f6e641a, 0x3f54db31, 0x3f316e2c, 0x3f78ed3c, 0x3f653a48, 0x3f45e403, 0x3f1c81b9
.long 0x3f737871, 0x3f5a46a0, 0x3f3504f3, 0x3f05c277, 0x3f6c835e, 0x3f4d9f02, 0x3f226799, 0x3edae880
.long 0x3f641901, 0x3f3f5cb5, 0x3f0e39da, 0x3ea7bf25, 0x3f5a46a0, 0x3f2f9c32, 0x3ef15aea, 0x3e6542e9
.long 0x3f4f1bbd, 0x3f1e7cf1, 0x3ec3ef15, 0x3df0b772, 0x3f42a9f7, 0x3f0c2124, 0x3e94a031, 0x3c20d8d2
.long 0x3f3504f3, 0x3ef15aea, 0x3e47c5c2, 0xbdc8bd36, 0x3f26423a, 0x3ec8917e, 0x3dc8bd36, 0xbe519f65
.long 0x00000000, 0x00000000, 0x00000000, 0x00000000, 0x3df0b772, 0x3e0255f4, 0x3e0c4cf7, 0x3e164083
.long 0x3e6f0c4d, 0x3e814693, 0x3e8afa3e, 0x3e94a031, 0x3eb13641, 0x3ebf47d7, 0x3ecd2ef3, 0x3edae880
.long 0x3ee87171, 0x3efa2c90, 0x3f05c277, 0x3f0e39da, 0x3f0e39da, 0x3f187fc0, 0x3f226799, 0x3f2beb4a
.long 0x3f26423a, 0x3f316e2c, 0x3f3bfc8f, 0x3f45e403, 0x3f3bfc8f, 0x3f4779bc, 0x3f5205d4, 0x3f5b941a
.long 0x3f4f1bbd, 0x3f5a46a0, 0x3f641901, 0x3f6c835e, 0x3f5f5be6, 0x3f698690, 0x3f71decf, 0x3f7853f8
.long 0x3f6c835e, 0x3f74fa0b, 0x3f7b14be, 0x3f7ec46d, 0x3f766377, 0x3f7c7160, 0x3f7f8e56, 0x3f7fb10f
.long 0x3f7cd925, 0x3f7fcd79, 0x3f7f35f9, 0x3f7b14be, 0x3f7fcd79, 0x3f7f0059, 0x3f7a0d54, 0x3f710908
.long 0x3f7f35f9, 0x3f7a0d54, 0x3f702d4f, 0x3f61c598, 0x3f7b14be, 0x3f710908, 0x3f61c598, 0x3f4d9f02
.long 0x3f737871, 0x3f641901, 0x3f4f1bbd, 0x3f3504f3, 0x3f687c12, 0x3f53731f, 0x3f3889dc, 0x3f187fc0
.long 0x3f5a46a0, 0x3f3f5cb5, 0x3f1e7cf1, 0x3ef15aea, 0x3f490a88, 0x3f28296a, 0x3f0172c3, 0x3eac7cd4
.long 0x3f3504f3, 0x3f0e39da, 0x3ec3ef15, 0x3e47c5c2, 0x3f1e7cf1, 0x3ee3f40d, 0x3e814693, 0x3d48fb30
.long 0x3f05c277, 0x3ea7bf25, 0x3df0b772, 0xbdc8bd36, 0x3ed65a92, 0x3e519f65, 0xbca0d6d6, 0xbe78cfcc
.long 0x3e9e377a, 0x3da0af2a, 0xbe20305b, 0xbec3ef15, 0x3e47c5c2, 0xbd48fb30, 0xbe94a031, 0xbf039c3d
.long 0x3da0af2a, 0xbe3403f1, 0xbed65a92, 0xbf226799, 0xbd20cee7, 0xbe996dba, 0xbf0a04f8, 0xbf3daef9
.long 0xbe20305b, 0xbed65a92, 0xbf26423a, 0xbf54db31, 0xbe8afa3e, 0xbf07e565, 0xbf3f5cb5, 0xbf676bd8
.long 0xbec3ef15, 0xbf226799, 0xbf54db31, 0xbf74fa0b, 0xbefa2c90, 0xbf3a4582, 0xbf6655e7, 0xbf7d3aac
.long 0x00000000, 0x00000000, 0x00000000, 0x00000000, 0x3e20305b, 0x3e2a1c3f, 0x3e3403f1, 0x3e3de731
.long 0x3e9e377a, 0x3ea7bf25, 0x3eb13641, 0x3eba9be1, 0x3ee87171, 0x3ef5c6c5, 0x3f0172c3, 0x3f07e565
.long 0x3f167918, 0x3f1e7cf1, 0x3f26423a, 0x3f2dc5e3, 0x3f3504f3, 0x3f3daef9, 0x3f45e403, 0x3f4d9f02
.long 0x3f4f1bbd, 0x3f579b8c, 0x3f5f5be6, 0x3f6655e7, 0x3f641901, 0x3f6b8a3d, 0x3f71decf, 0x3f770f11
.long 0x3f737871, 0x3f78ed3c, 0x3f7cd925, 0x3f7f35f9, 0x3f7cd925, 0x3f7f654e, 0x3f7ff35e, 0x3f7e8238
.long 0x3f800000, 0x3f7ec46d, 0x3f7b14be, 0x3f74fa0b, 0x3f7cd925, 0x3f770f11, 0x3f6e641a, 0x3f62f219
.long 0x3f737871, 0x3f687c12, 0x3f5a46a0, 0x3f490a88, 0x3f641901, 0x3f53731f, 0x3f3f5cb5, 0x3f28296a
.long 0x3f4f1bbd, 0x3f3889dc, 0x3f1e7cf1, 0x3f0172c3, 0x3f3504f3, 0x3f187fc0, 0x3ef15aea, 0x3eac7cd4
.long 0x3f167918, 0x3ee87171, 0x3e9e377a, 0x3e20305b, 0x3ee87171, 0x3e996dba, 0x3e0c4cf7, 0xbcf13d4c
.long 0x3e9e377a, 0x3e0c4cf7, 0xbd20cee7, 0xbe5b73dc, 0x3e20305b, 0xbcf13d4c, 0xbe5b73dc, 0xbec8917e
.long 0x250d3132, 0xbe47c5c2, 0xbec3ef15, 0xbf0e39da, 0xbe20305b, 0xbeb5eb4f, 0xbf0a04f8, 0xbf333bc6
.long 0xbe9e377a, 0xbf0172c3, 0xbf2dc5e3, 0xbf5205d4, 0xbee87171, 0xbf2456f1, 0xbf4c1d35, 0xbf698690
.long 0xbf167918, 0xbf42a9f7, 0xbf641901, 0xbf78ed3c, 0xbf3504f3, 0xbf5b941a, 0xbf74fa0b, 0xbf7fb10f
.long 0xbf4f1bbd, 0xbf6e641a, 0xbf7e39bc, 0xbf7d95f4, 0xbf641901, 0xbf7a9421, 0xbf7f8e56, 0xbf72ae9e
.long 0xbf737871, 0xbf7fcd79, 0xbf78ed3c, 0xbf5f5be6, 0xbf7cd925, 0xbf7deafa, 0xbf6a8b4b, 0xbf444969
.long 0xbf800000, 0xbf74fa0b, 0xbf54db31, 0xbf226799, 0xbf7cd925, 0xbf653a48, 0xbf3889dc, 0xbef5c6c5
.long 0x00000000, 0x00000000, 0x00000000, 0x00000000, 0x00000000, 0x00000000, 0x00000000, 0x00000000
.long 0x00000000, 0x00000000, 0x00000000, 0x00000000, 0x00000000, 0x00000000, 0x00000000, 0x00000000
.long 0x00000000, 0x00000000, 0x00000000, 0x00000000, 0x00000000, 0x00000000, 0x00000000, 0x00000000
.long 0x00000000, 0x00000000, 0x00000000, 0x00000000, 0x00000000, 0x00000000, 0x00000000, 0x00000000
.long 0x00000000, 0x00000000, 0x00000000, 0x00000000, 0x00000000, 0x00000000, 0x00000000, 0x00000000
.long 0x00000000, 0x00000000, 0x00000000, 0x00000000, 0x00000000, 0x00000000, 0x00000000, 0x00000000
.long 0x00000000, 0x00000000, 0x00000000, 0x00000000, 0x00000000, 0x00000000, 0x00000000, 0x00000000
.long 0x00000000, 0x00000000, 0x00000000, 0x00000000, 0x00000000, 0x00000000, 0x00000000, 0x00000000
.long 0x00000000, 0x00000000, 0x00000000, 0x00000000, 0x00000000, 0x00000000, 0x00000000, 0x00000000
.long 0x00000000, 0x00000000, 0x00000000, 0x00000000, 0x00000000, 0x00000000, 0x00000000, 0x00000000
.long 0x00000000, 0x00000000, 0x00000000, 0x00000000, 0x00000000, 0x00000000, 0x00000000, 0x00000000
.long 0x00000000, 0x00000000, 0x00000000, 0x00000000, 0x00000000, 0x00000000, 0x00000000, 0x00000000
.long 0x00000000, 0x00000000, 0x00000000, 0x00000000, 0x00000000, 0x00000000, 0x00000000, 0x00000000
.long 0x00000000, 0x00000000, 0x00000000, 0x00000000, 0x00000000, 0x00000000, 0x00000000, 0x00000000
.long 0x00000000, 0x00000000, 0x00000000, 0x00000000, 0x00000000, 0x00000000, 0x00000000, 0x00000000
.long 0x00000000, 0x00000000, 0x00000000, 0x00000000, 0x00000000, 0x00000000, 0x00000000, 0x00000000
.long 0x54005400, 0x54005400, 0x54005400, 0x54005400, 0x539c5400, 0x50b45279, 0xd39cd279, 0xd39cd400
.long 0x52795400, 0xccf24cf2, 0x52794cf2, 0x52795400, 0x50b45400, 0xd39cccf2, 0xd0b44cf2, 0xd0b4d400
.long 0x4cf25400, 0xd279d279, 0x4cf2d279, 0x4cf25400, 0x00005400, 0x8000d400, 0x00005400, 0x8000d400
.long 0xccf25400, 0x5279d279, 0xccf2d279, 0xccf25400, 0xd0b45400, 0x539cccf2, 0x50b44cf2, 0x50b4d400
.long 0xd2795400, 0x4cf24cf2, 0xd2794cf2, 0xd2795400, 0xd39c5400, 0xd0b45279, 0x539cd279, 0x539cd400
.long 0xd4005400, 0xd4005400, 0xd4005400, 0xd4005400, 0xd39c5400, 0xd0b45279, 0x539cd279, 0x539cd400
.long 0xd2795400, 0x4cf24cf2, 0xd2794cf2, 0xd2795400, 0xd0b45400, 0x539cccf2, 0x50b44cf2, 0x50b4d400
.long 0xccf25400, 0x5279d279, 0xccf2d279, 0xccf25400, 0x80005400, 0x0000d400, 0x80005400, 0x0000d400
.long 0x4cf25400, 0xd279d279, 0x4cf2d279, 0x4cf25400, 0x50b45400, 0xd39cccf2, 0xd0b44cf2, 0xd0b4d400
.long 0x52795400, 0xccf24cf2, 0x52794cf2, 0x52795400, 0x539c5400, 0x50b45279, 0xd39cd279, 0xd39cd400
.long 0x00000000, 0x00000000, 0x00000000, 0x00000000, 0x00000000, 0x00000000, 0x00000000, 0x00000000
.long 0x00000000, 0x00000000, 0x00000000, 0x00000000, 0x00000000, 0x00000000, 0x00000000, 0x00000000
.long 0x00000000, 0x00000000, 0x00000000, 0x00000000, 0x00000000, 0x00000000, 0x00000000, 0x00000000
.long 0x00000000, 0x00000000, 0x00000000, 0x00000000, 0x00000000, 0x00000000, 0x00000000, 0x00000000
.long 0x00000000, 0x00000000, 0x00000000, 0x00000000, 0x00000000, 0x00000000, 0x00000000, 0x00000000
.long 0x00000000, 0x00000000, 0x00000000, 0x00000000, 0x00000000, 0x00000000, 0x00000000, 0x00000000
.long 0x54005400, 0x54005400, 0x54005400, 0x54005400, 0x00004cf2, 0xd0b4ccf2, 0xd0b4d279, 0x8000ccf2
.long 0xd400d279, 0xccf2d279, 0xccf24cf2, 0xd400d279, 0x8000d279, 0x539c5279, 0x539c4cf2, 0x00005279
.long 0x54004cf2, 0xd2794cf2, 0xd279d279, 0x54004cf2, 0x00005400, 0x8000d400, 0x00005400, 0x8000d400
.long 0xd4004cf2, 0x52794cf2, 0x5279d279, 0xd4004cf2, 0x8000d279, 0xd39c5279, 0xd39c4cf2, 0x00005279
.long 0x5400d279, 0x4cf2d279, 0x4cf24cf2, 0x5400d279, 0x00004cf2, 0x50b4ccf2, 0x50b4d279, 0x8000ccf2
.long 0xd4005400, 0xd4005400, 0xd4005400, 0xd4005400, 0x80004cf2, 0x50b4ccf2, 0x50b4d279, 0x0000ccf2
.long 0x5400d279, 0x4cf2d279, 0x4cf24cf2, 0x5400d279, 0x0000d279, 0xd39c5279, 0xd39c4cf2, 0x80005279
.long 0xd4004cf2, 0x52794cf2, 0x5279d279, 0xd4004cf2, 0x80005400, 0x0000d400, 0x80005400, 0x0000d400
.long 0x54004cf2, 0xd2794cf2, 0xd279d279, 0x54004cf2, 0x0000d279, 0x539c5279, 0x539c4cf2, 0x80005279
.long 0xd400d279, 0xccf2d279, 0xccf24cf2, 0xd400d279, 0x80004cf2, 0xd0b4ccf2, 0xd0b4d279, 0x0000ccf2
.long 0x00000000, 0x00000000, 0x00000000, 0x00000000, 0x00000000, 0x00000000, 0x00000000, 0x00000000
.long 0x00000000, 0x00000000, 0x00000000, 0x00000000, 0x00000000, 0x00000000, 0x00000000, 0x00000000
.long 0x00000000, 0x00000000, 0x00000000, 0x00000000, 0x00000000, 0x00000000, 0x00000000, 0x00000000
.long 0x00000000, 0x00000000, 0x00000000, 0x00000000, 0x00000000, 0x00000000, 0x00000000, 0x00000000
.long 0x00000000, 0x00000000, 0x00000000, 0x00000000, 0x00000000, 0x00000000, 0x00000000, 0x00000000
.long 0x00000000, 0x00000000, 0x00000000, 0x00000000, 0x00000000, 0x00000000, 0x00000000, 0x00000000
.long 0x00000000, 0x00000000, 0x00000000, 0x00000000, 0x4cf20000, 0x527950b4, 0x4cf250b4, 0xccf20000
.long 0x50b40000, 0x539c539c, 0xd0b4d39c, 0x50b40000, 0x52790000, 0x4cf2539c, 0x5279539c, 0xd2790000
.long 0x539c0000, 0xd0b450b4, 0xd39cd0b4, 0x539c0000, 0x54000000, 0xd4000000, 0x54000000, 0xd4000000
.long 0x539c0000, 0xd0b4d0b4, 0xd39c50b4, 0x539c0000, 0x52790000, 0x4cf2d39c, 0x5279d39c, 0xd2790000
.long 0x50b40000, 0x539cd39c, 0xd0b4539c, 0x50b40000, 0x4cf20000, 0x5279d0b4, 0x4cf2d0b4, 0xccf20000
.long 0x00000000, 0x00000000, 0x00000000, 0x00000000, 0xccf20000, 0xd27950b4, 0xccf250b4, 0x4cf20000
.long 0xd0b40000, 0xd39c539c, 0x50b4d39c, 0xd0b40000, 0xd2790000, 0xccf2539c, 0xd279539c, 0x52790000
.long 0xd39c0000, 0x50b450b4, 0x539cd0b4, 0xd39c0000, 0xd4000000, 0x54000000, 0xd4000000, 0x54000000
.long 0xd39c0000, 0x50b4d0b4, 0x539c50b4, 0xd39c0000, 0xd2790000, 0xccf2d39c, 0xd279d39c, 0x52790000
.long 0xd0b40000, 0xd39cd39c, 0x50b4539c, 0xd0b40000, 0xccf20000, 0xd279d0b4, 0xccf2d0b4, 0x4cf20000
.long 0x00000000, 0x00000000, 0x00000000, 0x00000000, 0x00000000, 0x00000000, 0x00000000, 0x00000000
.long 0x00000000, 0x00000000, 0x00000000, 0x00000000, 0x00000000, 0x00000000, 0x00000000, 0x00000000
.long 0x00000000, 0x00000000, 0x00000000, 0x00000000, 0x00000000, 0x00000000, 0x00000000, 0x00000000
.long 0x00000000, 0x00000000, 0x00000000, 0x00000000, 0x00000000, 0x00000000, 0x00000000, 0x00000000
.long 0x00000000, 0x00000000, 0x00000000, 0x00000000, 0x00000000, 0x00000000, 0x00000000, 0x00000000
.long 0x00000000, 0x00000000, 0x00000000, 0x00000000, 0x00000000, 0x00000000, 0x00000000, 0x00000000
.long 0x00000000, 0x00000000, 0x00000000, 0x00000000, 0x5400539c, 0x5279539c, 0xd279d0b4, 0xd400d39c
.long 0x000050b4, 0xd39cd0b4, 0x539c539c, 0x000050b4, 0xd400d0b4, 0x4cf2d0b4, 0xccf2d39c, 0x540050b4
.long 0x0000d39c, 0x50b4539c, 0xd0b450b4, 0x0000d39c, 0x54000000, 0xd4000000, 0x54000000, 0xd4000000
.long 0x0000539c, 0x50b4d39c, 0xd0b4d0b4, 0x0000539c, 0xd40050b4, 0x4cf250b4, 0xccf2539c, 0x5400d0b4
.long 0x0000d0b4, 0xd39c50b4, 0x539cd39c, 0x0000d0b4, 0x5400d39c, 0x5279d39c, 0xd27950b4, 0xd400539c
.long 0x00000000, 0x00000000, 0x00000000, 0x00000000, 0xd400539c, 0xd279539c, 0x5279d0b4, 0x5400d39c
.long 0x000050b4, 0x539cd0b4, 0xd39c539c, 0x000050b4, 0x5400d0b4, 0xccf2d0b4, 0x4cf2d39c, 0xd40050b4
.long 0x0000d39c, 0xd0b4539c, 0x50b450b4, 0x0000d39c, 0xd4000000, 0x54000000, 0xd4000000, 0x54000000
.long 0x0000539c, 0xd0b4d39c, 0x50b4d0b4, 0x0000539c, 0x540050b4, 0xccf250b4, 0x4cf2539c, 0xd400d0b4
.long 0x0000d0b4, 0x539c50b4, 0xd39cd39c, 0x0000d0b4, 0xd400d39c, 0xd279d39c, 0x527950b4, 0x5400539c
.long 0x00000000, 0x00000000, 0x00000000, 0x00000000, 0x00000000, 0x00000000, 0x00000000, 0x00000000
.long 0x00000000, 0x00000000, 0x00000000, 0x00000000, 0x00000000, 0x00000000, 0x00000000, 0x00000000
.long 0x00000000, 0x00000000, 0x00000000, 0x00000000, 0x00000000, 0x00000000, 0x00000000, 0x00000000
.long 0x00000000, 0x00000000, 0x00000000, 0x00000000, 0x00000000, 0x00000000, 0x00000000, 0x00000000
.long 0x00000000, 0x00000000, 0x00000000, 0x00000000, 0x00000000, 0x00000000, 0x00000000, 0x00000000
.long 0x00000000, 0x00000000, 0x00000000, 0x00000000, 0x00000000, 0x00000000, 0x00000000, 0x00000000
.long 0x54005400, 0x54005400, 0x00000000, 0x00000000, 0x50b44cf2, 0x539c5279, 0xd279d39c, 0xccf2d0b4
.long 0xccf2d279, 0x52794cf2, 0xd39cd0b4, 0xd0b4d39c, 0xd39cd279, 0x50b4ccf2, 0xccf250b4, 0xd279d39c
.long 0xd2794cf2, 0x4cf2d279, 0x50b4539c, 0xd39cd0b4, 0x00005400, 0x8000d400, 0x54000000, 0xd4000000
.long 0x52794cf2, 0xccf2d279, 0x50b4d39c, 0xd39c50b4, 0x539cd279, 0xd0b4ccf2, 0xccf2d0b4, 0xd279539c
.long 0x4cf2d279, 0xd2794cf2, 0xd39c50b4, 0xd0b4539c, 0xd0b44cf2, 0xd39c5279, 0xd279539c, 0xccf250b4
.long 0xd4005400, 0xd4005400, 0x00000000, 0x00000000, 0xd0b44cf2, 0xd39c5279, 0x5279d39c, 0x4cf2d0b4
.long 0x4cf2d279, 0xd2794cf2, 0x539cd0b4, 0x50b4d39c, 0x539cd279, 0xd0b4ccf2, 0x4cf250b4, 0x5279d39c
.long 0x52794cf2, 0xccf2d279, 0xd0b4539c, 0x539cd0b4, 0x80005400, 0x0000d400, 0xd4000000, 0x54000000
.long 0xd2794cf2, 0x4cf2d279, 0xd0b4d39c, 0x539c50b4, 0xd39cd279, 0x50b4ccf2, 0x4cf2d0b4, 0x5279539c
.long 0xccf2d279, 0x52794cf2, 0x539c50b4, 0x50b4539c, 0x50b44cf2, 0x539c5279, 0x5279539c, 0x4cf250b4
.long 0x00000000, 0x00000000, 0x00000000, 0x00000000, 0x00000000, 0x00000000, 0x00000000, 0x00000000
.long 0x00000000, 0x00000000, 0x00000000, 0x00000000, 0x00000000, 0x00000000, 0x00000000, 0x00000000
.long 0x00000000, 0x00000000, 0x00000000, 0x00000000, 0x00000000, 0x00000000, 0x00000000, 0x00000000
.long 0x00000000, 0x00000000, 0x00000000, 0x00000000, 0x00000000, 0x00000000, 0x00000000, 0x00000000
.long 0x00000000, 0x00000000, 0x00000000, 0x00000000, 0x00000000, 0x00000000, 0x00000000, 0x00000000
.long 0x00000000, 0x00000000, 0x00000000, 0x00000000, 0x00000000, 0x00000000, 0x00000000, 0x00000000
.long 0x00000000, 0x00000000, 0x00000000, 0x00000000, 0x00000000, 0x00000000, 0x00000000, 0x00000000
.long 0x00000000, 0x00000000, 0x00000000, 0x00000000, 0x00000000, 0x00000000, 0x00000000, 0x00000000
.long 0x00000000, 0x00000000, 0x00000000, 0x00000000, 0x00000000, 0x00000000, 0x00000000, 0x00000000
.long 0x00000000, 0x00000000, 0x00000000, 0x00000000, 0x00000000, 0x00000000, 0x00000000, 0x00000000
.long 0x00000000, 0x00000000, 0x00000000, 0x00000000, 0x00000000, 0x00000000, 0x00000000, 0x00000000
.long 0x00000000, 0x00000000, 0x00000000, 0x00000000, 0x00000000, 0x00000000, 0x00000000, 0x00000000
.long 0x00000000, 0x00000000, 0x00000000, 0x00000000, 0x00000000, 0x00000000, 0x00000000, 0x00000000
.long 0x00000000, 0x00000000, 0x00000000, 0x00000000, 0x00000000, 0x00000000, 0x00000000, 0x00000000
.long 0x00000000, 0x00000000, 0x00000000, 0x00000000, 0x00000000, 0x00000000, 0x00000000, 0x00000000
.long 0x00000000, 0x00000000, 0x00000000, 0x00000000, 0x00000000, 0x00000000, 0x00000000, 0x00000000
.long 0x00000000, 0x00000000, 0x00000000, 0x00000000, 0x00000000, 0x00000000, 0x00000000, 0x00000000
.long 0x00000000, 0x00000000, 0x00000000, 0x00000000, 0x00000000, 0x00000000, 0x00000000, 0x00000000
.long 0x00000000, 0x00000000, 0x00000000, 0x00000000, 0x00000000, 0x00000000, 0x00000000, 0x00000000
.long 0x00000000, 0x00000000, 0x00000000, 0x00000000, 0x00000000, 0x00000000, 0x00000000, 0x00000000
.long 0x00000000, 0x00000000, 0x00000000, 0x00000000, 0x00000000, 0x00000000, 0x00000000, 0x00000000
.long 0x00000000, 0x00000000, 0x00000000, 0x00000000, 0x00000000, 0x00000000, 0x00000000, 0x00000000
.globl kc_kernel
.p2align 8
.type kc_kernel,@function
kc_kernel:

    s_cmp_ge_u32 s2, 256
    s_cbranch_scc1 L_kc_end
    s_load_dwordx2 s[4:5], s[0:1], 88
    v_lshrrev_b32 v1, 6, v0
    v_and_b32 v2, 63, v0
    v_readfirstlane_b32 s6, v1
    v_lshlrev_b32 v3, 4, v2
    s_and_b32 s7, s2, 7
    s_lshr_b32 s8, s2, 3
    s_and_b32 s9, s7, 1
    s_lshl_b32 s9, s9, 3
    s_and_b32 s10, s8, 7
    s_add_u32 s9, s9, s10
    s_lshr_b32 s10, s7, 1
    s_lshl_b32 s10, s10, 2
    s_lshr_b32 s11, s8, 3
    s_add_u32 s10, s10, s11
    s_mul_i32 s10, s10, 27
    s_lshr_b32 s10, s10, 2
    s_lshl_b32 s9, s9, 2
    s_add_u32 s9, s9, s6
    s_mul_i32 s11, s10, 40960
    s_lshl_b32 s31, s6, 10
    s_add_u32 s11, s11, s31
    v_add_u32 v4, s11, v3
    s_mov_b32 s24, 0
    s_mov_b32 s25, 40960
    s_mov_b32 s26, 81920
    s_mov_b32 s27, 122880
    s_mov_b32 s28, 163840
    s_mov_b32 s29, 204800
    s_mov_b32 s30, 245760
    s_mul_i32 s32, s9, 40960
    s_waitcnt lgkmcnt(0)
    s_add_u32 s12, s4, 7864320
    s_addc_u32 s13, s5, 0
    s_mov_b32 s14, 4423680
    s_mov_b32 s15, 0x00020000
    s_add_u32 s16, s4, 5242880
    s_addc_u32 s17, s5, 0
    s_mov_b32 s18, 2621440
    s_mov_b32 s19, 0x00020000
    s_add_u32 m0, s31, 0
    s_nop 0
    buffer_load_dwordx4 v4, s[12:15], s24 offen lds
    s_add_u32 s24, s24, 4096
    s_add_u32 m0, s31, 4096
    s_nop 0
    buffer_load_dwordx4 v4, s[12:15], s25 offen lds
    s_add_u32 s25, s25, 4096
    s_add_u32 m0, s31, 8192
    s_nop 0
    buffer_load_dwordx4 v4, s[12:15], s26 offen lds
    s_add_u32 s26, s26, 4096
    s_add_u32 m0, s31, 12288
    s_nop 0
    buffer_load_dwordx4 v4, s[12:15], s27 offen lds
    s_add_u32 s27, s27, 4096
    s_add_u32 m0, s31, 16384
    s_nop 0
    buffer_load_dwordx4 v4, s[12:15], s28 offen lds
    s_add_u32 s28, s28, 4096
    s_add_u32 m0, s31, 20480
    s_nop 0
    buffer_load_dwordx4 v4, s[12:15], s29 offen lds
    s_add_u32 s29, s29, 4096
    s_add_u32 m0, s31, 24576
    s_nop 0
    buffer_load_dwordx4 v4, s[12:15], s30 offen lds
    s_add_u32 s30, s30, 4096
    buffer_load_dwordx4 a[0:3], v3, s[16:19], s32 offen offset:0
    buffer_load_dwordx4 a[4:7], v3, s[16:19], s32 offen offset:1024
    buffer_load_dwordx4 a[8:11], v3, s[16:19], s32 offen offset:2048
    buffer_load_dwordx4 a[12:15], v3, s[16:19], s32 offen offset:3072
    s_add_u32 m0, s31, 28672
    s_nop 0
    buffer_load_dwordx4 v4, s[12:15], s24 offen lds
    s_add_u32 s24, s24, 4096
    s_add_u32 m0, s31, 32768
    s_nop 0
    buffer_load_dwordx4 v4, s[12:15], s25 offen lds
    s_add_u32 s25, s25, 4096
    s_add_u32 m0, s31, 36864
    s_nop 0
    buffer_load_dwordx4 v4, s[12:15], s26 offen lds
    s_add_u32 s26, s26, 4096
    s_add_u32 m0, s31, 40960
    s_nop 0
    buffer_load_dwordx4 v4, s[12:15], s27 offen lds
    s_add_u32 s27, s27, 4096
    s_add_u32 m0, s31, 45056
    s_nop 0
    buffer_load_dwordx4 v4, s[12:15], s28 offen lds
    s_add_u32 s28, s28, 4096
    s_add_u32 m0, s31, 49152
    s_nop 0
    buffer_load_dwordx4 v4, s[12:15], s29 offen lds
    s_add_u32 s29, s29, 4096
    s_add_u32 m0, s31, 53248
    s_nop 0
    buffer_load_dwordx4 v4, s[12:15], s30 offen lds
    s_add_u32 s30, s30, 4096
    s_add_u32 s20, s4, 14680064
    s_addc_u32 s21, s5, 0
    s_mov_b32 s22, 7077888
    s_mov_b32 s23, 0x00020000
    v_bfe_u32 v6, v2, 4, 1
    v_mul_u32_u24 v6, 55296, v6
    v_lshrrev_b32 v7, 5, v2
    v_lshlrev_b32 v7, 8, v7
    v_add_u32 v6, v6, v7
    v_and_b32 v7, 15, v2
    v_lshl_add_u32 v6, v7, 4, v6
    s_mul_i32 s33, s9, 110592
    s_lshl_b32 s34, s10, 9
    s_add_u32 s33, s33, s34
    s_mov_b32 s34, 0xbfb8aa3b
    s_mov_b32 s35, 0xbfb8aa3b
    s_mov_b32 s36, 1.0
    s_mov_b32 s37, 1.0
    s_waitcnt vmcnt(7)
    s_barrier
    v_mov_b32 v5, v3
    ds_read_b128 v[120:123], v5 offset:0
    ds_read_b128 v[124:127], v5 offset:4096
    ds_read_b128 v[128:131], v5 offset:8192
    ds_read_b128 v[132:135], v5 offset:12288
    ds_read_b128 v[136:139], v5 offset:16384
    ds_read_b128 v[140:143], v5 offset:20480
    ds_read_b128 v[144:147], v5 offset:24576
    v_add_u32 v7, 57344, v3
    v_add_u32 v209, 114688, v3
    s_waitcnt lgkmcnt(6)
    v_mfma_f32_32x32x16_bf16 v[8:23], v[120:123], a[0:3], 0
    ds_read_b128 v[148:151], v5 offset:1024
    s_add_u32 s32, s32, 4096
    buffer_load_dwordx4 a[16:19], v3, s[16:19], s32 offen offset:0
    s_waitcnt lgkmcnt(6)
    v_mfma_f32_32x32x16_bf16 v[24:39], v[124:127], a[0:3], 0
    ds_read_b128 v[152:155], v5 offset:5120
    buffer_load_dwordx4 a[20:23], v3, s[16:19], s32 offen offset:1024
    s_waitcnt lgkmcnt(6)
    v_mfma_f32_32x32x16_bf16 v[40:55], v[128:131], a[0:3], 0
    ds_read_b128 v[156:159], v5 offset:9216
    buffer_load_dwordx4 a[24:27], v3, s[16:19], s32 offen offset:2048
    s_waitcnt lgkmcnt(6)
    v_mfma_f32_32x32x16_bf16 v[56:71], v[132:135], a[0:3], 0
    ds_read_b128 v[160:163], v5 offset:13312
    buffer_load_dwordx4 a[28:31], v3, s[16:19], s32 offen offset:3072
    s_waitcnt lgkmcnt(6)
    v_mfma_f32_32x32x16_bf16 v[72:87], v[136:139], a[0:3], 0
    ds_read_b128 v[164:167], v5 offset:17408
    s_add_u32 m0, s31, 57344
    s_nop 0
    buffer_load_dwordx4 v4, s[12:15], s24 offen lds
    s_add_u32 s24, s24, 4096
    s_waitcnt lgkmcnt(6)
    v_mfma_f32_32x32x16_bf16 v[88:103], v[140:143], a[0:3], 0
    ds_read_b128 v[168:171], v5 offset:21504
    s_add_u32 m0, s31, 61440
    s_nop 0
    buffer_load_dwordx4 v4, s[12:15], s25 offen lds
    s_add_u32 s25, s25, 4096
    s_waitcnt lgkmcnt(6)
    v_mfma_f32_32x32x16_bf16 v[104:119], v[144:147], a[0:3], 0
    ds_read_b128 v[172:175], v5 offset:25600
    s_add_u32 m0, s31, 65536
    s_nop 0
    buffer_load_dwordx4 v4, s[12:15], s26 offen lds
    s_add_u32 s26, s26, 4096
    s_waitcnt lgkmcnt(6)
    v_mfma_f32_32x32x16_bf16 v[8:23], v[148:151], a[4:7], v[8:23]
    ds_read_b128 v[120:123], v5 offset:2048
    s_add_u32 m0, s31, 69632
    s_nop 0
    buffer_load_dwordx4 v4, s[12:15], s27 offen lds
    s_add_u32 s27, s27, 4096
    s_waitcnt lgkmcnt(6)
    v_mfma_f32_32x32x16_bf16 v[24:39], v[152:155], a[4:7], v[24:39]
    ds_read_b128 v[124:127], v5 offset:6144
    s_add_u32 m0, s31, 73728
    s_nop 0
    buffer_load_dwordx4 v4, s[12:15], s28 offen lds
    s_add_u32 s28, s28, 4096
    s_waitcnt lgkmcnt(6)
    v_mfma_f32_32x32x16_bf16 v[40:55], v[156:159], a[4:7], v[40:55]
    ds_read_b128 v[128:131], v5 offset:10240
    s_add_u32 m0, s31, 77824
    s_nop 0
    buffer_load_dwordx4 v4, s[12:15], s29 offen lds
    s_add_u32 s29, s29, 4096
    s_waitcnt lgkmcnt(6)
    v_mfma_f32_32x32x16_bf16 v[56:71], v[160:163], a[4:7], v[56:71]
    ds_read_b128 v[132:135], v5 offset:14336
    s_add_u32 m0, s31, 81920
    s_nop 0
    buffer_load_dwordx4 v4, s[12:15], s30 offen lds
    s_add_u32 s30, s30, 4096
    s_waitcnt lgkmcnt(6)
    v_mfma_f32_32x32x16_bf16 v[72:87], v[164:167], a[4:7], v[72:87]
    ds_read_b128 v[136:139], v5 offset:18432
    s_add_u32 s32, s32, 4096
    buffer_load_dwordx4 a[32:35], v3, s[16:19], s32 offen offset:0
    s_waitcnt lgkmcnt(6)
    v_mfma_f32_32x32x16_bf16 v[88:103], v[168:171], a[4:7], v[88:103]
    ds_read_b128 v[140:143], v5 offset:22528
    buffer_load_dwordx4 a[36:39], v3, s[16:19], s32 offen offset:1024
    s_waitcnt lgkmcnt(6)
    v_mfma_f32_32x32x16_bf16 v[104:119], v[172:175], a[4:7], v[104:119]
    ds_read_b128 v[144:147], v5 offset:26624
    buffer_load_dwordx4 a[40:43], v3, s[16:19], s32 offen offset:2048
    s_waitcnt lgkmcnt(6)
    v_mfma_f32_32x32x16_bf16 v[8:23], v[120:123], a[8:11], v[8:23]
    ds_read_b128 v[148:151], v5 offset:3072
    buffer_load_dwordx4 a[44:47], v3, s[16:19], s32 offen offset:3072
    s_waitcnt lgkmcnt(6)
    v_mfma_f32_32x32x16_bf16 v[24:39], v[124:127], a[8:11], v[24:39]
    ds_read_b128 v[152:155], v5 offset:7168
    s_add_u32 m0, s31, 86016
    s_nop 0
    buffer_load_dwordx4 v4, s[12:15], s24 offen lds
    s_add_u32 s24, s24, 4096
    s_waitcnt lgkmcnt(6)
    v_mfma_f32_32x32x16_bf16 v[40:55], v[128:131], a[8:11], v[40:55]
    ds_read_b128 v[156:159], v5 offset:11264
    s_add_u32 m0, s31, 90112
    s_nop 0
    buffer_load_dwordx4 v4, s[12:15], s25 offen lds
    s_add_u32 s25, s25, 4096
    s_waitcnt lgkmcnt(6)
    v_mfma_f32_32x32x16_bf16 v[56:71], v[132:135], a[8:11], v[56:71]
    ds_read_b128 v[160:163], v5 offset:15360
    s_add_u32 m0, s31, 94208
    s_nop 0
    buffer_load_dwordx4 v4, s[12:15], s26 offen lds
    s_add_u32 s26, s26, 4096
    s_waitcnt lgkmcnt(6)
    v_mfma_f32_32x32x16_bf16 v[72:87], v[136:139], a[8:11], v[72:87]
    ds_read_b128 v[164:167], v5 offset:19456
    s_add_u32 m0, s31, 98304
    s_nop 0
    buffer_load_dwordx4 v4, s[12:15], s27 offen lds
    s_add_u32 s27, s27, 4096
    s_waitcnt lgkmcnt(6)
    v_mfma_f32_32x32x16_bf16 v[88:103], v[140:143], a[8:11], v[88:103]
    ds_read_b128 v[168:171], v5 offset:23552
    s_add_u32 m0, s31, 102400
    s_nop 0
    buffer_load_dwordx4 v4, s[12:15], s28 offen lds
    s_add_u32 s28, s28, 4096
    s_waitcnt lgkmcnt(6)
    v_mfma_f32_32x32x16_bf16 v[104:119], v[144:147], a[8:11], v[104:119]
    ds_read_b128 v[172:175], v5 offset:27648
    s_add_u32 m0, s31, 106496
    s_nop 0
    buffer_load_dwordx4 v4, s[12:15], s29 offen lds
    s_add_u32 s29, s29, 4096
    s_waitcnt vmcnt(17) lgkmcnt(0)
    s_barrier
    v_add_u32 v5, 28672, v3
    v_mfma_f32_32x32x16_bf16 v[8:23], v[148:151], a[12:15], v[8:23]
    ds_read_b128 v[120:123], v5 offset:0
    s_add_u32 m0, s31, 110592
    s_nop 0
    buffer_load_dwordx4 v4, s[12:15], s30 offen lds
    s_add_u32 s30, s30, 4096
    v_mfma_f32_32x32x16_bf16 v[24:39], v[152:155], a[12:15], v[24:39]
    ds_read_b128 v[124:127], v5 offset:4096
    s_add_u32 s32, s32, 4096
    buffer_load_dwordx4 a[48:51], v3, s[16:19], s32 offen offset:0
    v_mfma_f32_32x32x16_bf16 v[40:55], v[156:159], a[12:15], v[40:55]
    ds_read_b128 v[128:131], v5 offset:8192
    buffer_load_dwordx4 a[52:55], v3, s[16:19], s32 offen offset:1024
    v_mfma_f32_32x32x16_bf16 v[56:71], v[160:163], a[12:15], v[56:71]
    ds_read_b128 v[132:135], v5 offset:12288
    buffer_load_dwordx4 a[56:59], v3, s[16:19], s32 offen offset:2048
    v_mfma_f32_32x32x16_bf16 v[72:87], v[164:167], a[12:15], v[72:87]
    ds_read_b128 v[136:139], v5 offset:16384
    buffer_load_dwordx4 a[60:63], v3, s[16:19], s32 offen offset:3072
    v_mfma_f32_32x32x16_bf16 v[88:103], v[168:171], a[12:15], v[88:103]
    ds_read_b128 v[140:143], v5 offset:20480
    s_add_u32 m0, s31, 114688
    s_nop 0
    buffer_load_dwordx4 v4, s[12:15], s24 offen lds
    s_add_u32 s24, s24, 4096
    v_mfma_f32_32x32x16_bf16 v[104:119], v[172:175], a[12:15], v[104:119]
    ds_read_b128 v[144:147], v5 offset:24576
    s_add_u32 m0, s31, 118784
    s_nop 0
    buffer_load_dwordx4 v4, s[12:15], s25 offen lds
    s_add_u32 s25, s25, 4096
    s_waitcnt lgkmcnt(6)
    v_mfma_f32_32x32x16_bf16 v[8:23], v[120:123], a[16:19], v[8:23]
    ds_read_b128 v[148:151], v5 offset:1024
    s_add_u32 m0, s31, 122880
    s_nop 0
    buffer_load_dwordx4 v4, s[12:15], s26 offen lds
    s_add_u32 s26, s26, 4096
    s_waitcnt lgkmcnt(6)
    v_mfma_f32_32x32x16_bf16 v[24:39], v[124:127], a[16:19], v[24:39]
    ds_read_b128 v[152:155], v5 offset:5120
    s_add_u32 m0, s31, 126976
    s_nop 0
    buffer_load_dwordx4 v4, s[12:15], s27 offen lds
    s_add_u32 s27, s27, 4096
    s_waitcnt lgkmcnt(6)
    v_mfma_f32_32x32x16_bf16 v[40:55], v[128:131], a[16:19], v[40:55]
    ds_read_b128 v[156:159], v5 offset:9216
    s_add_u32 m0, s31, 131072
    s_nop 0
    buffer_load_dwordx4 v4, s[12:15], s28 offen lds
    s_add_u32 s28, s28, 4096
    s_waitcnt lgkmcnt(6)
    v_mfma_f32_32x32x16_bf16 v[56:71], v[132:135], a[16:19], v[56:71]
    ds_read_b128 v[160:163], v5 offset:13312
    s_add_u32 m0, s31, 135168
    s_nop 0
    buffer_load_dwordx4 v4, s[12:15], s29 offen lds
    s_add_u32 s29, s29, 4096
    s_waitcnt lgkmcnt(6)
    v_mfma_f32_32x32x16_bf16 v[72:87], v[136:139], a[16:19], v[72:87]
    ds_read_b128 v[164:167], v5 offset:17408
    s_add_u32 m0, s31, 139264
    s_nop 0
    buffer_load_dwordx4 v4, s[12:15], s30 offen lds
    s_add_u32 s30, s30, 4096
    s_waitcnt lgkmcnt(6)
    v_mfma_f32_32x32x16_bf16 v[88:103], v[140:143], a[16:19], v[88:103]
    ds_read_b128 v[168:171], v5 offset:21504
    s_add_u32 s32, s32, 4096
    buffer_load_dwordx4 a[64:67], v3, s[16:19], s32 offen offset:0
    s_waitcnt lgkmcnt(6)
    v_mfma_f32_32x32x16_bf16 v[104:119], v[144:147], a[16:19], v[104:119]
    ds_read_b128 v[172:175], v5 offset:25600
    buffer_load_dwordx4 a[68:71], v3, s[16:19], s32 offen offset:1024
    s_waitcnt lgkmcnt(6)
    v_mfma_f32_32x32x16_bf16 v[8:23], v[148:151], a[20:23], v[8:23]
    ds_read_b128 v[120:123], v5 offset:2048
    buffer_load_dwordx4 a[72:75], v3, s[16:19], s32 offen offset:2048
    s_waitcnt lgkmcnt(6)
    v_mfma_f32_32x32x16_bf16 v[24:39], v[152:155], a[20:23], v[24:39]
    ds_read_b128 v[124:127], v5 offset:6144
    buffer_load_dwordx4 a[76:79], v3, s[16:19], s32 offen offset:3072
    s_waitcnt lgkmcnt(6)
    v_mfma_f32_32x32x16_bf16 v[40:55], v[156:159], a[20:23], v[40:55]
    ds_read_b128 v[128:131], v5 offset:10240
    s_add_u32 m0, s31, 0
    s_nop 0
    buffer_load_dwordx4 v4, s[12:15], s24 offen lds
    s_add_u32 s24, s24, 4096
    s_waitcnt lgkmcnt(6)
    v_mfma_f32_32x32x16_bf16 v[56:71], v[160:163], a[20:23], v[56:71]
    ds_read_b128 v[132:135], v5 offset:14336
    s_add_u32 m0, s31, 4096
    s_nop 0
    buffer_load_dwordx4 v4, s[12:15], s25 offen lds
    s_add_u32 s25, s25, 4096
    s_waitcnt lgkmcnt(6)
    v_mfma_f32_32x32x16_bf16 v[72:87], v[164:167], a[20:23], v[72:87]
    ds_read_b128 v[136:139], v5 offset:18432
    s_add_u32 m0, s31, 8192
    s_nop 0
    buffer_load_dwordx4 v4, s[12:15], s26 offen lds
    s_add_u32 s26, s26, 4096
    s_waitcnt lgkmcnt(6)
    v_mfma_f32_32x32x16_bf16 v[88:103], v[168:171], a[20:23], v[88:103]
    ds_read_b128 v[140:143], v5 offset:22528
    s_add_u32 m0, s31, 12288
    s_nop 0
    buffer_load_dwordx4 v4, s[12:15], s27 offen lds
    s_add_u32 s27, s27, 4096
    s_waitcnt lgkmcnt(6)
    v_mfma_f32_32x32x16_bf16 v[104:119], v[172:175], a[20:23], v[104:119]
    ds_read_b128 v[144:147], v5 offset:26624
    s_add_u32 m0, s31, 16384
    s_nop 0
    buffer_load_dwordx4 v4, s[12:15], s28 offen lds
    s_add_u32 s28, s28, 4096
    s_waitcnt lgkmcnt(6)
    v_mfma_f32_32x32x16_bf16 v[8:23], v[120:123], a[24:27], v[8:23]
    ds_read_b128 v[148:151], v5 offset:3072
    s_add_u32 m0, s31, 20480
    s_nop 0
    buffer_load_dwordx4 v4, s[12:15], s29 offen lds
    s_add_u32 s29, s29, 4096
    s_waitcnt lgkmcnt(6)
    v_mfma_f32_32x32x16_bf16 v[24:39], v[124:127], a[24:27], v[24:39]
    ds_read_b128 v[152:155], v5 offset:7168
    s_add_u32 m0, s31, 24576
    s_nop 0
    buffer_load_dwordx4 v4, s[12:15], s30 offen lds
    s_add_u32 s30, s30, 4096
    s_waitcnt lgkmcnt(6)
    v_mfma_f32_32x32x16_bf16 v[40:55], v[128:131], a[24:27], v[40:55]
    ds_read_b128 v[156:159], v5 offset:11264
    s_add_u32 s32, s32, 4096
    buffer_load_dwordx4 a[80:83], v3, s[16:19], s32 offen offset:0
    s_waitcnt lgkmcnt(6)
    v_mfma_f32_32x32x16_bf16 v[56:71], v[132:135], a[24:27], v[56:71]
    ds_read_b128 v[160:163], v5 offset:15360
    buffer_load_dwordx4 a[84:87], v3, s[16:19], s32 offen offset:1024
    s_waitcnt lgkmcnt(6)
    v_mfma_f32_32x32x16_bf16 v[72:87], v[136:139], a[24:27], v[72:87]
    ds_read_b128 v[164:167], v5 offset:19456
    buffer_load_dwordx4 a[88:91], v3, s[16:19], s32 offen offset:2048
    s_waitcnt lgkmcnt(6)
    v_mfma_f32_32x32x16_bf16 v[88:103], v[140:143], a[24:27], v[88:103]
    ds_read_b128 v[168:171], v5 offset:23552
    buffer_load_dwordx4 a[92:95], v3, s[16:19], s32 offen offset:3072
    s_waitcnt lgkmcnt(6)
    v_mfma_f32_32x32x16_bf16 v[104:119], v[144:147], a[24:27], v[104:119]
    ds_read_b128 v[172:175], v5 offset:27648
    s_waitcnt vmcnt(33) lgkmcnt(0)
    s_barrier
    v_add_u32 v5, 57344, v3
    v_mfma_f32_32x32x16_bf16 v[8:23], v[148:151], a[28:31], v[8:23]
    ds_read_b128 v[120:123], v5 offset:0
    s_add_u32 m0, s31, 28672
    s_nop 0
    buffer_load_dwordx4 v4, s[12:15], s24 offen lds
    s_add_u32 s24, s24, 4096
    v_mfma_f32_32x32x16_bf16 v[24:39], v[152:155], a[28:31], v[24:39]
    ds_read_b128 v[124:127], v5 offset:4096
    s_add_u32 m0, s31, 32768
    s_nop 0
    buffer_load_dwordx4 v4, s[12:15], s25 offen lds
    s_add_u32 s25, s25, 4096
    v_mfma_f32_32x32x16_bf16 v[40:55], v[156:159], a[28:31], v[40:55]
    ds_read_b128 v[128:131], v5 offset:8192
    s_add_u32 m0, s31, 36864
    s_nop 0
    buffer_load_dwordx4 v4, s[12:15], s26 offen lds
    s_add_u32 s26, s26, 4096
    v_mfma_f32_32x32x16_bf16 v[56:71], v[160:163], a[28:31], v[56:71]
    ds_read_b128 v[132:135], v5 offset:12288
    s_add_u32 m0, s31, 40960
    s_nop 0
    buffer_load_dwordx4 v4, s[12:15], s27 offen lds
    s_add_u32 s27, s27, 4096
    v_mfma_f32_32x32x16_bf16 v[72:87], v[164:167], a[28:31], v[72:87]
    ds_read_b128 v[136:139], v5 offset:16384
    s_add_u32 m0, s31, 45056
    s_nop 0
    buffer_load_dwordx4 v4, s[12:15], s28 offen lds
    s_add_u32 s28, s28, 4096
    v_mfma_f32_32x32x16_bf16 v[88:103], v[168:171], a[28:31], v[88:103]
    ds_read_b128 v[140:143], v5 offset:20480
    s_add_u32 m0, s31, 49152
    s_nop 0
    buffer_load_dwordx4 v4, s[12:15], s29 offen lds
    s_add_u32 s29, s29, 4096
    v_mfma_f32_32x32x16_bf16 v[104:119], v[172:175], a[28:31], v[104:119]
    ds_read_b128 v[144:147], v5 offset:24576
    s_add_u32 m0, s31, 53248
    s_nop 0
    buffer_load_dwordx4 v4, s[12:15], s30 offen lds
    s_add_u32 s30, s30, 4096
    s_waitcnt lgkmcnt(6)
    v_mfma_f32_32x32x16_bf16 v[8:23], v[120:123], a[32:35], v[8:23]
    ds_read_b128 v[148:151], v5 offset:1024
    s_add_u32 s32, s32, 4096
    buffer_load_dwordx4 a[96:99], v3, s[16:19], s32 offen offset:0
    s_waitcnt lgkmcnt(6)
    v_mfma_f32_32x32x16_bf16 v[24:39], v[124:127], a[32:35], v[24:39]
    ds_read_b128 v[152:155], v5 offset:5120
    buffer_load_dwordx4 a[100:103], v3, s[16:19], s32 offen offset:1024
    s_waitcnt lgkmcnt(6)
    v_mfma_f32_32x32x16_bf16 v[40:55], v[128:131], a[32:35], v[40:55]
    ds_read_b128 v[156:159], v5 offset:9216
    buffer_load_dwordx4 a[104:107], v3, s[16:19], s32 offen offset:2048
    s_waitcnt lgkmcnt(6)
    v_mfma_f32_32x32x16_bf16 v[56:71], v[132:135], a[32:35], v[56:71]
    ds_read_b128 v[160:163], v5 offset:13312
    buffer_load_dwordx4 a[108:111], v3, s[16:19], s32 offen offset:3072
    s_waitcnt lgkmcnt(6)
    v_mfma_f32_32x32x16_bf16 v[72:87], v[136:139], a[32:35], v[72:87]
    ds_read_b128 v[164:167], v5 offset:17408
    s_waitcnt lgkmcnt(6)
    v_mfma_f32_32x32x16_bf16 v[88:103], v[140:143], a[32:35], v[88:103]
    ds_read_b128 v[168:171], v5 offset:21504
    s_waitcnt lgkmcnt(6)
    v_mfma_f32_32x32x16_bf16 v[104:119], v[144:147], a[32:35], v[104:119]
    ds_read_b128 v[172:175], v5 offset:25600
    s_waitcnt lgkmcnt(6)
    v_mfma_f32_32x32x16_bf16 v[8:23], v[148:151], a[36:39], v[8:23]
    ds_read_b128 v[120:123], v5 offset:2048
    s_waitcnt lgkmcnt(6)
    v_mfma_f32_32x32x16_bf16 v[24:39], v[152:155], a[36:39], v[24:39]
    ds_read_b128 v[124:127], v5 offset:6144
    s_waitcnt lgkmcnt(6)
    v_mfma_f32_32x32x16_bf16 v[40:55], v[156:159], a[36:39], v[40:55]
    ds_read_b128 v[128:131], v5 offset:10240
    s_waitcnt lgkmcnt(6)
    v_mfma_f32_32x32x16_bf16 v[56:71], v[160:163], a[36:39], v[56:71]
    ds_read_b128 v[132:135], v5 offset:14336
    s_waitcnt lgkmcnt(6)
    v_mfma_f32_32x32x16_bf16 v[72:87], v[164:167], a[36:39], v[72:87]
    ds_read_b128 v[136:139], v5 offset:18432
    s_waitcnt lgkmcnt(6)
    v_mfma_f32_32x32x16_bf16 v[88:103], v[168:171], a[36:39], v[88:103]
    ds_read_b128 v[140:143], v5 offset:22528
    s_waitcnt lgkmcnt(6)
    v_mfma_f32_32x32x16_bf16 v[104:119], v[172:175], a[36:39], v[104:119]
    ds_read_b128 v[144:147], v5 offset:26624
    s_waitcnt lgkmcnt(6)
    v_mfma_f32_32x32x16_bf16 v[8:23], v[120:123], a[40:43], v[8:23]
    ds_read_b128 v[148:151], v5 offset:3072
    s_waitcnt lgkmcnt(6)
    v_mfma_f32_32x32x16_bf16 v[24:39], v[124:127], a[40:43], v[24:39]
    ds_read_b128 v[152:155], v5 offset:7168
    s_waitcnt lgkmcnt(6)
    v_mfma_f32_32x32x16_bf16 v[40:55], v[128:131], a[40:43], v[40:55]
    ds_read_b128 v[156:159], v5 offset:11264
    s_waitcnt lgkmcnt(6)
    v_mfma_f32_32x32x16_bf16 v[56:71], v[132:135], a[40:43], v[56:71]
    ds_read_b128 v[160:163], v5 offset:15360
    s_waitcnt lgkmcnt(6)
    v_mfma_f32_32x32x16_bf16 v[72:87], v[136:139], a[40:43], v[72:87]
    ds_read_b128 v[164:167], v5 offset:19456
    s_waitcnt lgkmcnt(6)
    v_mfma_f32_32x32x16_bf16 v[88:103], v[140:143], a[40:43], v[88:103]
    ds_read_b128 v[168:171], v5 offset:23552
    s_waitcnt lgkmcnt(6)
    v_mfma_f32_32x32x16_bf16 v[104:119], v[144:147], a[40:43], v[104:119]
    ds_read_b128 v[172:175], v5 offset:27648
    s_waitcnt vmcnt(33) lgkmcnt(0)
    s_barrier
    v_add_u32 v5, 86016, v3
    v_mfma_f32_32x32x16_bf16 v[8:23], v[148:151], a[44:47], v[8:23]
    ds_read_b128 v[120:123], v5 offset:0
    s_add_u32 m0, s31, 57344
    s_nop 0
    buffer_load_dwordx4 v4, s[12:15], s24 offen lds
    s_add_u32 s24, s24, 4096
    v_mfma_f32_32x32x16_bf16 v[24:39], v[152:155], a[44:47], v[24:39]
    ds_read_b128 v[124:127], v5 offset:4096
    s_add_u32 m0, s31, 61440
    s_nop 0
    buffer_load_dwordx4 v4, s[12:15], s25 offen lds
    s_add_u32 s25, s25, 4096
    v_mfma_f32_32x32x16_bf16 v[40:55], v[156:159], a[44:47], v[40:55]
    ds_read_b128 v[128:131], v5 offset:8192
    s_add_u32 m0, s31, 65536
    s_nop 0
    buffer_load_dwordx4 v4, s[12:15], s26 offen lds
    s_add_u32 s26, s26, 4096
    v_mfma_f32_32x32x16_bf16 v[56:71], v[160:163], a[44:47], v[56:71]
    ds_read_b128 v[132:135], v5 offset:12288
    s_add_u32 m0, s31, 69632
    s_nop 0
    buffer_load_dwordx4 v4, s[12:15], s27 offen lds
    s_add_u32 s27, s27, 4096
    v_mfma_f32_32x32x16_bf16 v[72:87], v[164:167], a[44:47], v[72:87]
    ds_read_b128 v[136:139], v5 offset:16384
    s_add_u32 m0, s31, 73728
    s_nop 0
    buffer_load_dwordx4 v4, s[12:15], s28 offen lds
    s_add_u32 s28, s28, 4096
    v_mfma_f32_32x32x16_bf16 v[88:103], v[168:171], a[44:47], v[88:103]
    ds_read_b128 v[140:143], v5 offset:20480
    s_add_u32 m0, s31, 77824
    s_nop 0
    buffer_load_dwordx4 v4, s[12:15], s29 offen lds
    s_add_u32 s29, s29, 4096
    v_mfma_f32_32x32x16_bf16 v[104:119], v[172:175], a[44:47], v[104:119]
    ds_read_b128 v[144:147], v5 offset:24576
    s_add_u32 m0, s31, 81920
    s_nop 0
    buffer_load_dwordx4 v4, s[12:15], s30 offen lds
    s_add_u32 s30, s30, 4096
    s_waitcnt lgkmcnt(6)
    v_mfma_f32_32x32x16_bf16 v[8:23], v[120:123], a[48:51], v[8:23]
    ds_read_b128 v[148:151], v5 offset:1024
    s_add_u32 s32, s32, 4096
    buffer_load_dwordx4 a[112:115], v3, s[16:19], s32 offen offset:0
    s_waitcnt lgkmcnt(6)
    v_mfma_f32_32x32x16_bf16 v[24:39], v[124:127], a[48:51], v[24:39]
    ds_read_b128 v[152:155], v5 offset:5120
    buffer_load_dwordx4 a[116:119], v3, s[16:19], s32 offen offset:1024
    s_waitcnt lgkmcnt(6)
    v_mfma_f32_32x32x16_bf16 v[40:55], v[128:131], a[48:51], v[40:55]
    ds_read_b128 v[156:159], v5 offset:9216
    buffer_load_dwordx4 a[120:123], v3, s[16:19], s32 offen offset:2048
    s_waitcnt lgkmcnt(6)
    v_mfma_f32_32x32x16_bf16 v[56:71], v[132:135], a[48:51], v[56:71]
    ds_read_b128 v[160:163], v5 offset:13312
    buffer_load_dwordx4 a[124:127], v3, s[16:19], s32 offen offset:3072
    s_waitcnt lgkmcnt(6)
    v_mfma_f32_32x32x16_bf16 v[72:87], v[136:139], a[48:51], v[72:87]
    ds_read_b128 v[164:167], v5 offset:17408
    s_waitcnt lgkmcnt(6)
    v_mfma_f32_32x32x16_bf16 v[88:103], v[140:143], a[48:51], v[88:103]
    ds_read_b128 v[168:171], v5 offset:21504
    s_waitcnt lgkmcnt(6)
    v_mfma_f32_32x32x16_bf16 v[104:119], v[144:147], a[48:51], v[104:119]
    ds_read_b128 v[172:175], v5 offset:25600
    s_waitcnt lgkmcnt(6)
    v_mfma_f32_32x32x16_bf16 v[8:23], v[148:151], a[52:55], v[8:23]
    ds_read_b128 v[120:123], v5 offset:2048
    s_waitcnt lgkmcnt(6)
    v_mfma_f32_32x32x16_bf16 v[24:39], v[152:155], a[52:55], v[24:39]
    ds_read_b128 v[124:127], v5 offset:6144
    s_waitcnt lgkmcnt(6)
    v_mfma_f32_32x32x16_bf16 v[40:55], v[156:159], a[52:55], v[40:55]
    ds_read_b128 v[128:131], v5 offset:10240
    s_waitcnt lgkmcnt(6)
    v_mfma_f32_32x32x16_bf16 v[56:71], v[160:163], a[52:55], v[56:71]
    ds_read_b128 v[132:135], v5 offset:14336
    s_waitcnt lgkmcnt(6)
    v_mfma_f32_32x32x16_bf16 v[72:87], v[164:167], a[52:55], v[72:87]
    ds_read_b128 v[136:139], v5 offset:18432
    s_waitcnt lgkmcnt(6)
    v_mfma_f32_32x32x16_bf16 v[88:103], v[168:171], a[52:55], v[88:103]
    ds_read_b128 v[140:143], v5 offset:22528
    s_waitcnt lgkmcnt(6)
    v_mfma_f32_32x32x16_bf16 v[104:119], v[172:175], a[52:55], v[104:119]
    ds_read_b128 v[144:147], v5 offset:26624
    s_waitcnt lgkmcnt(6)
    v_mfma_f32_32x32x16_bf16 v[8:23], v[120:123], a[56:59], v[8:23]
    ds_read_b128 v[148:151], v5 offset:3072
    s_waitcnt lgkmcnt(6)
    v_mfma_f32_32x32x16_bf16 v[24:39], v[124:127], a[56:59], v[24:39]
    ds_read_b128 v[152:155], v5 offset:7168
    s_waitcnt lgkmcnt(6)
    v_mfma_f32_32x32x16_bf16 v[40:55], v[128:131], a[56:59], v[40:55]
    ds_read_b128 v[156:159], v5 offset:11264
    s_waitcnt lgkmcnt(6)
    v_mfma_f32_32x32x16_bf16 v[56:71], v[132:135], a[56:59], v[56:71]
    ds_read_b128 v[160:163], v5 offset:15360
    s_waitcnt lgkmcnt(6)
    v_mfma_f32_32x32x16_bf16 v[72:87], v[136:139], a[56:59], v[72:87]
    ds_read_b128 v[164:167], v5 offset:19456
    s_waitcnt lgkmcnt(6)
    v_mfma_f32_32x32x16_bf16 v[88:103], v[140:143], a[56:59], v[88:103]
    ds_read_b128 v[168:171], v5 offset:23552
    s_waitcnt lgkmcnt(6)
    v_mfma_f32_32x32x16_bf16 v[104:119], v[144:147], a[56:59], v[104:119]
    ds_read_b128 v[172:175], v5 offset:27648
    s_waitcnt vmcnt(33) lgkmcnt(0)
    s_barrier
    v_add_u32 v5, 114688, v3
    v_mfma_f32_32x32x16_bf16 v[8:23], v[148:151], a[60:63], v[8:23]
    ds_read_b128 v[120:123], v5 offset:0
    s_add_u32 m0, s31, 86016
    s_nop 0
    buffer_load_dwordx4 v4, s[12:15], s24 offen lds
    s_add_u32 s24, s24, 4096
    v_mfma_f32_32x32x16_bf16 v[24:39], v[152:155], a[60:63], v[24:39]
    ds_read_b128 v[124:127], v5 offset:4096
    s_add_u32 m0, s31, 90112
    s_nop 0
    buffer_load_dwordx4 v4, s[12:15], s25 offen lds
    s_add_u32 s25, s25, 4096
    v_mfma_f32_32x32x16_bf16 v[40:55], v[156:159], a[60:63], v[40:55]
    ds_read_b128 v[128:131], v5 offset:8192
    s_add_u32 m0, s31, 94208
    s_nop 0
    buffer_load_dwordx4 v4, s[12:15], s26 offen lds
    s_add_u32 s26, s26, 4096
    v_mfma_f32_32x32x16_bf16 v[56:71], v[160:163], a[60:63], v[56:71]
    ds_read_b128 v[132:135], v5 offset:12288
    s_add_u32 m0, s31, 98304
    s_nop 0
    buffer_load_dwordx4 v4, s[12:15], s27 offen lds
    s_add_u32 s27, s27, 4096
    v_mfma_f32_32x32x16_bf16 v[72:87], v[164:167], a[60:63], v[72:87]
    ds_read_b128 v[136:139], v5 offset:16384
    s_add_u32 m0, s31, 102400
    s_nop 0
    buffer_load_dwordx4 v4, s[12:15], s28 offen lds
    s_add_u32 s28, s28, 4096
    v_mfma_f32_32x32x16_bf16 v[88:103], v[168:171], a[60:63], v[88:103]
    ds_read_b128 v[140:143], v5 offset:20480
    s_add_u32 m0, s31, 106496
    s_nop 0
    buffer_load_dwordx4 v4, s[12:15], s29 offen lds
    s_add_u32 s29, s29, 4096
    v_mfma_f32_32x32x16_bf16 v[104:119], v[172:175], a[60:63], v[104:119]
    ds_read_b128 v[144:147], v5 offset:24576
    s_add_u32 m0, s31, 110592
    s_nop 0
    buffer_load_dwordx4 v4, s[12:15], s30 offen lds
    s_add_u32 s30, s30, 4096
    s_waitcnt lgkmcnt(6)
    v_mfma_f32_32x32x16_bf16 v[8:23], v[120:123], a[64:67], v[8:23]
    ds_read_b128 v[148:151], v5 offset:1024
    s_add_u32 s32, s32, 4096
    buffer_load_dwordx4 a[128:131], v3, s[16:19], s32 offen offset:0
    s_waitcnt lgkmcnt(6)
    v_mfma_f32_32x32x16_bf16 v[24:39], v[124:127], a[64:67], v[24:39]
    ds_read_b128 v[152:155], v5 offset:5120
    buffer_load_dwordx4 a[132:135], v3, s[16:19], s32 offen offset:1024
    s_waitcnt lgkmcnt(6)
    v_mfma_f32_32x32x16_bf16 v[40:55], v[128:131], a[64:67], v[40:55]
    ds_read_b128 v[156:159], v5 offset:9216
    buffer_load_dwordx4 a[136:139], v3, s[16:19], s32 offen offset:2048
    s_waitcnt lgkmcnt(6)
    v_mfma_f32_32x32x16_bf16 v[56:71], v[132:135], a[64:67], v[56:71]
    ds_read_b128 v[160:163], v5 offset:13312
    buffer_load_dwordx4 a[140:143], v3, s[16:19], s32 offen offset:3072
    s_waitcnt lgkmcnt(6)
    v_mfma_f32_32x32x16_bf16 v[72:87], v[136:139], a[64:67], v[72:87]
    ds_read_b128 v[164:167], v5 offset:17408
    s_waitcnt lgkmcnt(6)
    v_mfma_f32_32x32x16_bf16 v[88:103], v[140:143], a[64:67], v[88:103]
    ds_read_b128 v[168:171], v5 offset:21504
    s_waitcnt lgkmcnt(6)
    v_mfma_f32_32x32x16_bf16 v[104:119], v[144:147], a[64:67], v[104:119]
    ds_read_b128 v[172:175], v5 offset:25600
    s_waitcnt lgkmcnt(6)
    v_mfma_f32_32x32x16_bf16 v[8:23], v[148:151], a[68:71], v[8:23]
    ds_read_b128 v[120:123], v5 offset:2048
    s_waitcnt lgkmcnt(6)
    v_mfma_f32_32x32x16_bf16 v[24:39], v[152:155], a[68:71], v[24:39]
    ds_read_b128 v[124:127], v5 offset:6144
    s_waitcnt lgkmcnt(6)
    v_mfma_f32_32x32x16_bf16 v[40:55], v[156:159], a[68:71], v[40:55]
    ds_read_b128 v[128:131], v5 offset:10240
    s_waitcnt lgkmcnt(6)
    v_mfma_f32_32x32x16_bf16 v[56:71], v[160:163], a[68:71], v[56:71]
    ds_read_b128 v[132:135], v5 offset:14336
    s_waitcnt lgkmcnt(6)
    v_mfma_f32_32x32x16_bf16 v[72:87], v[164:167], a[68:71], v[72:87]
    ds_read_b128 v[136:139], v5 offset:18432
    s_waitcnt lgkmcnt(6)
    v_mfma_f32_32x32x16_bf16 v[88:103], v[168:171], a[68:71], v[88:103]
    ds_read_b128 v[140:143], v5 offset:22528
    s_waitcnt lgkmcnt(6)
    v_mfma_f32_32x32x16_bf16 v[104:119], v[172:175], a[68:71], v[104:119]
    ds_read_b128 v[144:147], v5 offset:26624
    s_waitcnt lgkmcnt(6)
    v_mfma_f32_32x32x16_bf16 v[8:23], v[120:123], a[72:75], v[8:23]
    ds_read_b128 v[148:151], v5 offset:3072
    s_waitcnt lgkmcnt(6)
    v_mfma_f32_32x32x16_bf16 v[24:39], v[124:127], a[72:75], v[24:39]
    ds_read_b128 v[152:155], v5 offset:7168
    s_waitcnt lgkmcnt(6)
    v_mfma_f32_32x32x16_bf16 v[40:55], v[128:131], a[72:75], v[40:55]
    ds_read_b128 v[156:159], v5 offset:11264
    s_waitcnt lgkmcnt(6)
    v_mfma_f32_32x32x16_bf16 v[56:71], v[132:135], a[72:75], v[56:71]
    ds_read_b128 v[160:163], v5 offset:15360
    s_waitcnt lgkmcnt(6)
    v_mfma_f32_32x32x16_bf16 v[72:87], v[136:139], a[72:75], v[72:87]
    ds_read_b128 v[164:167], v5 offset:19456
    s_waitcnt lgkmcnt(6)
    v_mfma_f32_32x32x16_bf16 v[88:103], v[140:143], a[72:75], v[88:103]
    ds_read_b128 v[168:171], v5 offset:23552
    s_waitcnt lgkmcnt(6)
    v_mfma_f32_32x32x16_bf16 v[104:119], v[144:147], a[72:75], v[104:119]
    ds_read_b128 v[172:175], v5 offset:27648
    s_waitcnt vmcnt(33) lgkmcnt(0)
    s_barrier
    v_add_u32 v5, 0, v3
    v_mfma_f32_32x32x16_bf16 v[8:23], v[148:151], a[76:79], v[8:23]
    ds_read_b128 v[120:123], v5 offset:0
    s_add_u32 m0, s31, 114688
    s_nop 0
    buffer_load_dwordx4 v4, s[12:15], s24 offen lds
    s_add_u32 s24, s24, 4096
    v_mfma_f32_32x32x16_bf16 v[24:39], v[152:155], a[76:79], v[24:39]
    ds_read_b128 v[124:127], v5 offset:4096
    s_add_u32 m0, s31, 118784
    s_nop 0
    buffer_load_dwordx4 v4, s[12:15], s25 offen lds
    s_add_u32 s25, s25, 4096
    v_mfma_f32_32x32x16_bf16 v[40:55], v[156:159], a[76:79], v[40:55]
    ds_read_b128 v[128:131], v5 offset:8192
    s_add_u32 m0, s31, 122880
    s_nop 0
    buffer_load_dwordx4 v4, s[12:15], s26 offen lds
    s_add_u32 s26, s26, 4096
    v_mfma_f32_32x32x16_bf16 v[56:71], v[160:163], a[76:79], v[56:71]
    ds_read_b128 v[132:135], v5 offset:12288
    s_add_u32 m0, s31, 126976
    s_nop 0
    buffer_load_dwordx4 v4, s[12:15], s27 offen lds
    s_add_u32 s27, s27, 4096
    v_mfma_f32_32x32x16_bf16 v[72:87], v[164:167], a[76:79], v[72:87]
    ds_read_b128 v[136:139], v5 offset:16384
    s_add_u32 m0, s31, 131072
    s_nop 0
    buffer_load_dwordx4 v4, s[12:15], s28 offen lds
    s_add_u32 s28, s28, 4096
    v_mfma_f32_32x32x16_bf16 v[88:103], v[168:171], a[76:79], v[88:103]
    ds_read_b128 v[140:143], v5 offset:20480
    s_add_u32 m0, s31, 135168
    s_nop 0
    buffer_load_dwordx4 v4, s[12:15], s29 offen lds
    s_add_u32 s29, s29, 4096
    v_mfma_f32_32x32x16_bf16 v[104:119], v[172:175], a[76:79], v[104:119]
    ds_read_b128 v[144:147], v5 offset:24576
    s_add_u32 m0, s31, 139264
    s_nop 0
    buffer_load_dwordx4 v4, s[12:15], s30 offen lds
    s_add_u32 s30, s30, 4096
    s_waitcnt lgkmcnt(6)
    v_mfma_f32_32x32x16_bf16 v[8:23], v[120:123], a[80:83], v[8:23]
    ds_read_b128 v[148:151], v5 offset:1024
    s_add_u32 s32, s32, 4096
    buffer_load_dwordx4 a[144:147], v3, s[16:19], s32 offen offset:0
    s_waitcnt lgkmcnt(6)
    v_mfma_f32_32x32x16_bf16 v[24:39], v[124:127], a[80:83], v[24:39]
    ds_read_b128 v[152:155], v5 offset:5120
    buffer_load_dwordx4 a[148:151], v3, s[16:19], s32 offen offset:1024
    s_waitcnt lgkmcnt(6)
    v_mfma_f32_32x32x16_bf16 v[40:55], v[128:131], a[80:83], v[40:55]
    ds_read_b128 v[156:159], v5 offset:9216
    buffer_load_dwordx4 a[152:155], v3, s[16:19], s32 offen offset:2048
    s_waitcnt lgkmcnt(6)
    v_mfma_f32_32x32x16_bf16 v[56:71], v[132:135], a[80:83], v[56:71]
    ds_read_b128 v[160:163], v5 offset:13312
    buffer_load_dwordx4 a[156:159], v3, s[16:19], s32 offen offset:3072
    s_waitcnt lgkmcnt(6)
    v_mfma_f32_32x32x16_bf16 v[72:87], v[136:139], a[80:83], v[72:87]
    ds_read_b128 v[164:167], v5 offset:17408
    s_waitcnt lgkmcnt(6)
    v_mfma_f32_32x32x16_bf16 v[88:103], v[140:143], a[80:83], v[88:103]
    ds_read_b128 v[168:171], v5 offset:21504
    s_waitcnt lgkmcnt(6)
    v_mfma_f32_32x32x16_bf16 v[104:119], v[144:147], a[80:83], v[104:119]
    ds_read_b128 v[172:175], v5 offset:25600
    s_waitcnt lgkmcnt(6)
    v_mfma_f32_32x32x16_bf16 v[8:23], v[148:151], a[84:87], v[8:23]
    ds_read_b128 v[120:123], v5 offset:2048
    s_waitcnt lgkmcnt(6)
    v_mfma_f32_32x32x16_bf16 v[24:39], v[152:155], a[84:87], v[24:39]
    ds_read_b128 v[124:127], v5 offset:6144
    s_waitcnt lgkmcnt(6)
    v_mfma_f32_32x32x16_bf16 v[40:55], v[156:159], a[84:87], v[40:55]
    ds_read_b128 v[128:131], v5 offset:10240
    s_waitcnt lgkmcnt(6)
    v_mfma_f32_32x32x16_bf16 v[56:71], v[160:163], a[84:87], v[56:71]
    ds_read_b128 v[132:135], v5 offset:14336
    s_waitcnt lgkmcnt(6)
    v_mfma_f32_32x32x16_bf16 v[72:87], v[164:167], a[84:87], v[72:87]
    ds_read_b128 v[136:139], v5 offset:18432
    s_waitcnt lgkmcnt(6)
    v_mfma_f32_32x32x16_bf16 v[88:103], v[168:171], a[84:87], v[88:103]
    ds_read_b128 v[140:143], v5 offset:22528
    s_waitcnt lgkmcnt(6)
    v_mfma_f32_32x32x16_bf16 v[104:119], v[172:175], a[84:87], v[104:119]
    ds_read_b128 v[144:147], v5 offset:26624
    s_waitcnt lgkmcnt(6)
    v_mfma_f32_32x32x16_bf16 v[8:23], v[120:123], a[88:91], v[8:23]
    ds_read_b128 v[148:151], v5 offset:3072
    s_waitcnt lgkmcnt(6)
    v_mfma_f32_32x32x16_bf16 v[24:39], v[124:127], a[88:91], v[24:39]
    ds_read_b128 v[152:155], v5 offset:7168
    s_waitcnt lgkmcnt(6)
    v_mfma_f32_32x32x16_bf16 v[40:55], v[128:131], a[88:91], v[40:55]
    ds_read_b128 v[156:159], v5 offset:11264
    s_waitcnt lgkmcnt(6)
    v_mfma_f32_32x32x16_bf16 v[56:71], v[132:135], a[88:91], v[56:71]
    ds_read_b128 v[160:163], v5 offset:15360
    s_waitcnt lgkmcnt(6)
    v_mfma_f32_32x32x16_bf16 v[72:87], v[136:139], a[88:91], v[72:87]
    ds_read_b128 v[164:167], v5 offset:19456
    s_waitcnt lgkmcnt(6)
    v_mfma_f32_32x32x16_bf16 v[88:103], v[140:143], a[88:91], v[88:103]
    ds_read_b128 v[168:171], v5 offset:23552
    s_waitcnt lgkmcnt(6)
    v_mfma_f32_32x32x16_bf16 v[104:119], v[144:147], a[88:91], v[104:119]
    ds_read_b128 v[172:175], v5 offset:27648
    s_waitcnt vmcnt(33) lgkmcnt(0)
    s_barrier
    v_add_u32 v5, 28672, v3
    v_mfma_f32_32x32x16_bf16 v[8:23], v[148:151], a[92:95], v[8:23]
    ds_read_b128 v[120:123], v5 offset:0
    v_mfma_f32_32x32x16_bf16 v[24:39], v[152:155], a[92:95], v[24:39]
    ds_read_b128 v[124:127], v5 offset:4096
    v_mfma_f32_32x32x16_bf16 v[40:55], v[156:159], a[92:95], v[40:55]
    ds_read_b128 v[128:131], v5 offset:8192
    v_mfma_f32_32x32x16_bf16 v[56:71], v[160:163], a[92:95], v[56:71]
    ds_read_b128 v[132:135], v5 offset:12288
    v_mfma_f32_32x32x16_bf16 v[72:87], v[164:167], a[92:95], v[72:87]
    ds_read_b128 v[136:139], v5 offset:16384
    v_mfma_f32_32x32x16_bf16 v[88:103], v[168:171], a[92:95], v[88:103]
    ds_read_b128 v[140:143], v5 offset:20480
    v_mfma_f32_32x32x16_bf16 v[104:119], v[172:175], a[92:95], v[104:119]
    ds_read_b128 v[144:147], v5 offset:24576
    s_waitcnt lgkmcnt(6)
    v_mfma_f32_32x32x16_bf16 v[8:23], v[120:123], a[96:99], v[8:23]
    ds_read_b128 v[148:151], v5 offset:1024
    s_waitcnt lgkmcnt(6)
    v_mfma_f32_32x32x16_bf16 v[24:39], v[124:127], a[96:99], v[24:39]
    ds_read_b128 v[152:155], v5 offset:5120
    s_waitcnt lgkmcnt(6)
    v_mfma_f32_32x32x16_bf16 v[40:55], v[128:131], a[96:99], v[40:55]
    ds_read_b128 v[156:159], v5 offset:9216
    s_waitcnt lgkmcnt(6)
    v_mfma_f32_32x32x16_bf16 v[56:71], v[132:135], a[96:99], v[56:71]
    ds_read_b128 v[160:163], v5 offset:13312
    s_waitcnt lgkmcnt(6)
    v_mfma_f32_32x32x16_bf16 v[72:87], v[136:139], a[96:99], v[72:87]
    ds_read_b128 v[164:167], v5 offset:17408
    s_waitcnt lgkmcnt(6)
    v_mfma_f32_32x32x16_bf16 v[88:103], v[140:143], a[96:99], v[88:103]
    ds_read_b128 v[168:171], v5 offset:21504
    s_waitcnt lgkmcnt(6)
    v_mfma_f32_32x32x16_bf16 v[104:119], v[144:147], a[96:99], v[104:119]
    ds_read_b128 v[172:175], v5 offset:25600
    s_waitcnt lgkmcnt(6)
    v_mfma_f32_32x32x16_bf16 v[8:23], v[148:151], a[100:103], v[8:23]
    ds_read_b128 v[120:123], v5 offset:2048
    s_waitcnt lgkmcnt(6)
    v_mfma_f32_32x32x16_bf16 v[24:39], v[152:155], a[100:103], v[24:39]
    ds_read_b128 v[124:127], v5 offset:6144
    s_waitcnt lgkmcnt(6)
    v_mfma_f32_32x32x16_bf16 v[40:55], v[156:159], a[100:103], v[40:55]
    ds_read_b128 v[128:131], v5 offset:10240
    s_waitcnt lgkmcnt(6)
    v_mfma_f32_32x32x16_bf16 v[56:71], v[160:163], a[100:103], v[56:71]
    ds_read_b128 v[132:135], v5 offset:14336
    s_waitcnt lgkmcnt(6)
    v_mfma_f32_32x32x16_bf16 v[72:87], v[164:167], a[100:103], v[72:87]
    ds_read_b128 v[136:139], v5 offset:18432
    s_waitcnt lgkmcnt(6)
    v_mfma_f32_32x32x16_bf16 v[88:103], v[168:171], a[100:103], v[88:103]
    ds_read_b128 v[140:143], v5 offset:22528
    s_waitcnt lgkmcnt(6)
    v_mfma_f32_32x32x16_bf16 v[104:119], v[172:175], a[100:103], v[104:119]
    ds_read_b128 v[144:147], v5 offset:26624
    s_waitcnt lgkmcnt(6)
    v_mfma_f32_32x32x16_bf16 v[8:23], v[120:123], a[104:107], v[8:23]
    ds_read_b128 v[148:151], v5 offset:3072
    s_waitcnt lgkmcnt(6)
    v_mfma_f32_32x32x16_bf16 v[24:39], v[124:127], a[104:107], v[24:39]
    ds_read_b128 v[152:155], v5 offset:7168
    s_waitcnt lgkmcnt(6)
    v_mfma_f32_32x32x16_bf16 v[40:55], v[128:131], a[104:107], v[40:55]
    ds_read_b128 v[156:159], v5 offset:11264
    s_waitcnt lgkmcnt(6)
    v_mfma_f32_32x32x16_bf16 v[56:71], v[132:135], a[104:107], v[56:71]
    ds_read_b128 v[160:163], v5 offset:15360
    s_waitcnt lgkmcnt(6)
    v_mfma_f32_32x32x16_bf16 v[72:87], v[136:139], a[104:107], v[72:87]
    ds_read_b128 v[164:167], v5 offset:19456
    s_waitcnt lgkmcnt(6)
    v_mfma_f32_32x32x16_bf16 v[88:103], v[140:143], a[104:107], v[88:103]
    ds_read_b128 v[168:171], v5 offset:23552
    s_waitcnt lgkmcnt(6)
    v_mfma_f32_32x32x16_bf16 v[104:119], v[144:147], a[104:107], v[104:119]
    ds_read_b128 v[172:175], v5 offset:27648
    s_waitcnt vmcnt(0) lgkmcnt(0)
    s_barrier
    v_add_u32 v5, 57344, v3
    v_mfma_f32_32x32x16_bf16 v[8:23], v[148:151], a[108:111], v[8:23]
    ds_read_b128 v[120:123], v7 offset:0
    v_mfma_f32_32x32x16_bf16 v[24:39], v[152:155], a[108:111], v[24:39]
    ds_read_b128 v[124:127], v7 offset:1024
    v_mfma_f32_32x32x16_bf16 v[40:55], v[156:159], a[108:111], v[40:55]
    ds_read_b128 v[128:131], v7 offset:2048
    v_mfma_f32_32x32x16_bf16 v[56:71], v[160:163], a[108:111], v[56:71]
    ds_read_b128 v[132:135], v7 offset:3072
    v_mfma_f32_32x32x16_bf16 v[72:87], v[164:167], a[108:111], v[72:87]
    ds_read_b128 v[136:139], v7 offset:28672
    v_mfma_f32_32x32x16_bf16 v[88:103], v[168:171], a[108:111], v[88:103]
    ds_read_b128 v[140:143], v7 offset:29696
    v_mfma_f32_32x32x16_bf16 v[104:119], v[172:175], a[108:111], v[104:119]
    ds_read_b128 v[144:147], v7 offset:30720
    ds_read_b128 v[148:151], v7 offset:31744
    s_waitcnt lgkmcnt(7)
    v_mfma_f32_32x32x16_bf16 v[8:23], v[120:123], a[112:115], v[8:23]
    ds_read_b128 v[152:155], v209 offset:0
    s_waitcnt lgkmcnt(7)
    v_mfma_f32_32x32x16_bf16 v[8:23], v[124:127], a[116:119], v[8:23]
    ds_read_b128 v[156:159], v209 offset:1024
    s_waitcnt lgkmcnt(7)
    v_mfma_f32_32x32x16_bf16 v[8:23], v[128:131], a[120:123], v[8:23]
    ds_read_b128 v[160:163], v209 offset:2048
    s_waitcnt lgkmcnt(7)
    v_mfma_f32_32x32x16_bf16 v[8:23], v[132:135], a[124:127], v[8:23]
    ds_read_b128 v[164:167], v209 offset:3072
    s_waitcnt lgkmcnt(7)
    v_mfma_f32_32x32x16_bf16 v[8:23], v[136:139], a[128:131], v[8:23]
    ds_read_b128 v[168:171], v7 offset:4096
    s_waitcnt lgkmcnt(7)
    v_mfma_f32_32x32x16_bf16 v[8:23], v[140:143], a[132:135], v[8:23]
    ds_read_b128 v[172:175], v7 offset:5120
    s_waitcnt lgkmcnt(7)
    v_mfma_f32_32x32x16_bf16 v[8:23], v[144:147], a[136:139], v[8:23]
    ds_read_b128 v[176:179], v7 offset:6144
    s_waitcnt lgkmcnt(7)
    v_mfma_f32_32x32x16_bf16 v[8:23], v[148:151], a[140:143], v[8:23]
    ds_read_b128 v[180:183], v7 offset:7168
    s_waitcnt lgkmcnt(7)
    v_mfma_f32_32x32x16_bf16 v[8:23], v[152:155], a[144:147], v[8:23]
    ds_read_b128 v[120:123], v7 offset:32768
    s_waitcnt lgkmcnt(7)
    v_mfma_f32_32x32x16_bf16 v[8:23], v[156:159], a[148:151], v[8:23]
    ds_read_b128 v[124:127], v7 offset:33792
    s_waitcnt lgkmcnt(7)
    v_mfma_f32_32x32x16_bf16 v[8:23], v[160:163], a[152:155], v[8:23]
    ds_read_b128 v[128:131], v7 offset:34816
    s_waitcnt lgkmcnt(7)
    v_mfma_f32_32x32x16_bf16 v[8:23], v[164:167], a[156:159], v[8:23]
    ds_read_b128 v[132:135], v7 offset:35840
    s_waitcnt lgkmcnt(7)
    v_mfma_f32_32x32x16_bf16 v[24:39], v[168:171], a[112:115], v[24:39]
    ds_read_b128 v[136:139], v209 offset:4096
    s_waitcnt lgkmcnt(7)
    v_mfma_f32_32x32x16_bf16 v[24:39], v[172:175], a[116:119], v[24:39]
    ds_read_b128 v[140:143], v209 offset:5120
    s_nop 4
    v_pk_mul_f32 v[184:185], v[8:9], s[34:35]
    v_pk_mul_f32 v[186:187], v[10:11], s[34:35]
    v_pk_mul_f32 v[188:189], v[12:13], s[34:35]
    s_waitcnt lgkmcnt(7)
    v_mfma_f32_32x32x16_bf16 v[24:39], v[176:179], a[120:123], v[24:39]
    ds_read_b128 v[144:147], v209 offset:6144
    v_pk_mul_f32 v[190:191], v[14:15], s[34:35]
    v_exp_f32 v184, v184
    v_exp_f32 v185, v185
    s_waitcnt lgkmcnt(7)
    v_mfma_f32_32x32x16_bf16 v[24:39], v[180:183], a[124:127], v[24:39]
    ds_read_b128 v[148:151], v209 offset:7168
    v_exp_f32 v186, v186
    v_exp_f32 v187, v187
    v_exp_f32 v188, v188
    s_waitcnt lgkmcnt(7)
    v_mfma_f32_32x32x16_bf16 v[24:39], v[120:123], a[128:131], v[24:39]
    ds_read_b128 v[152:155], v7 offset:8192
    v_exp_f32 v189, v189
    v_exp_f32 v190, v190
    v_exp_f32 v191, v191
    s_waitcnt lgkmcnt(7)
    v_mfma_f32_32x32x16_bf16 v[24:39], v[124:127], a[132:135], v[24:39]
    ds_read_b128 v[156:159], v7 offset:9216
    v_pk_add_f32 v[184:185], v[184:185], s[36:37]
    v_pk_add_f32 v[186:187], v[186:187], s[36:37]
    v_pk_add_f32 v[188:189], v[188:189], s[36:37]
    s_waitcnt lgkmcnt(7)
    v_mfma_f32_32x32x16_bf16 v[24:39], v[128:131], a[136:139], v[24:39]
    ds_read_b128 v[160:163], v7 offset:10240
    v_pk_add_f32 v[190:191], v[190:191], s[36:37]
    v_rcp_f32 v184, v184
    v_rcp_f32 v185, v185
    s_waitcnt lgkmcnt(7)
    v_mfma_f32_32x32x16_bf16 v[24:39], v[132:135], a[140:143], v[24:39]
    ds_read_b128 v[164:167], v7 offset:11264
    v_rcp_f32 v186, v186
    v_rcp_f32 v187, v187
    v_rcp_f32 v188, v188
    s_waitcnt lgkmcnt(7)
    v_mfma_f32_32x32x16_bf16 v[24:39], v[136:139], a[144:147], v[24:39]
    ds_read_b128 v[168:171], v7 offset:36864
    v_rcp_f32 v189, v189
    v_rcp_f32 v190, v190
    v_rcp_f32 v191, v191
    s_waitcnt lgkmcnt(7)
    v_mfma_f32_32x32x16_bf16 v[24:39], v[140:143], a[148:151], v[24:39]
    ds_read_b128 v[172:175], v7 offset:37888
    v_pk_mul_f32 v[184:185], v[184:185], v[16:17]
    v_pk_mul_f32 v[186:187], v[186:187], v[18:19]
    v_pk_mul_f32 v[188:189], v[188:189], v[20:21]
    s_waitcnt lgkmcnt(7)
    v_mfma_f32_32x32x16_bf16 v[24:39], v[144:147], a[152:155], v[24:39]
    ds_read_b128 v[176:179], v7 offset:38912
    v_pk_mul_f32 v[190:191], v[190:191], v[22:23]
    v_cvt_pk_bf16_f32 v192, v184, v185
    v_cvt_pk_bf16_f32 v193, v186, v187
    s_waitcnt lgkmcnt(7)
    v_mfma_f32_32x32x16_bf16 v[24:39], v[148:151], a[156:159], v[24:39]
    ds_read_b128 v[180:183], v7 offset:39936
    v_cvt_pk_bf16_f32 v194, v188, v189
    v_cvt_pk_bf16_f32 v195, v190, v191
    buffer_store_dwordx4 v[192:195], v6, s[20:23], s33 offen offset:0
    s_waitcnt lgkmcnt(7)
    v_mfma_f32_32x32x16_bf16 v[40:55], v[152:155], a[112:115], v[40:55]
    ds_read_b128 v[120:123], v209 offset:8192
    s_waitcnt lgkmcnt(7)
    v_mfma_f32_32x32x16_bf16 v[40:55], v[156:159], a[116:119], v[40:55]
    ds_read_b128 v[124:127], v209 offset:9216
    s_nop 1
    v_pk_mul_f32 v[196:197], v[24:25], s[34:35]
    v_pk_mul_f32 v[198:199], v[26:27], s[34:35]
    v_pk_mul_f32 v[200:201], v[28:29], s[34:35]
    s_waitcnt lgkmcnt(7)
    v_mfma_f32_32x32x16_bf16 v[40:55], v[160:163], a[120:123], v[40:55]
    ds_read_b128 v[128:131], v209 offset:10240
    v_pk_mul_f32 v[202:203], v[30:31], s[34:35]
    v_exp_f32 v196, v196
    v_exp_f32 v197, v197
    s_waitcnt lgkmcnt(7)
    v_mfma_f32_32x32x16_bf16 v[40:55], v[164:167], a[124:127], v[40:55]
    ds_read_b128 v[132:135], v209 offset:11264
    v_exp_f32 v198, v198
    v_exp_f32 v199, v199
    v_exp_f32 v200, v200
    s_waitcnt lgkmcnt(7)
    v_mfma_f32_32x32x16_bf16 v[40:55], v[168:171], a[128:131], v[40:55]
    ds_read_b128 v[136:139], v7 offset:12288
    v_exp_f32 v201, v201
    v_exp_f32 v202, v202
    v_exp_f32 v203, v203
    s_waitcnt lgkmcnt(7)
    v_mfma_f32_32x32x16_bf16 v[40:55], v[172:175], a[132:135], v[40:55]
    ds_read_b128 v[140:143], v7 offset:13312
    v_pk_add_f32 v[196:197], v[196:197], s[36:37]
    v_pk_add_f32 v[198:199], v[198:199], s[36:37]
    v_pk_add_f32 v[200:201], v[200:201], s[36:37]
    s_waitcnt lgkmcnt(7)
    v_mfma_f32_32x32x16_bf16 v[40:55], v[176:179], a[136:139], v[40:55]
    ds_read_b128 v[144:147], v7 offset:14336
    v_pk_add_f32 v[202:203], v[202:203], s[36:37]
    v_rcp_f32 v196, v196
    v_rcp_f32 v197, v197
    s_waitcnt lgkmcnt(7)
    v_mfma_f32_32x32x16_bf16 v[40:55], v[180:183], a[140:143], v[40:55]
    ds_read_b128 v[148:151], v7 offset:15360
    v_rcp_f32 v198, v198
    v_rcp_f32 v199, v199
    v_rcp_f32 v200, v200
    s_waitcnt lgkmcnt(7)
    v_mfma_f32_32x32x16_bf16 v[40:55], v[120:123], a[144:147], v[40:55]
    ds_read_b128 v[152:155], v7 offset:40960
    v_rcp_f32 v201, v201
    v_rcp_f32 v202, v202
    v_rcp_f32 v203, v203
    s_waitcnt lgkmcnt(7)
    v_mfma_f32_32x32x16_bf16 v[40:55], v[124:127], a[148:151], v[40:55]
    ds_read_b128 v[156:159], v7 offset:41984
    v_pk_mul_f32 v[196:197], v[196:197], v[32:33]
    v_pk_mul_f32 v[198:199], v[198:199], v[34:35]
    v_pk_mul_f32 v[200:201], v[200:201], v[36:37]
    s_waitcnt lgkmcnt(7)
    v_mfma_f32_32x32x16_bf16 v[40:55], v[128:131], a[152:155], v[40:55]
    ds_read_b128 v[160:163], v7 offset:43008
    v_pk_mul_f32 v[202:203], v[202:203], v[38:39]
    v_cvt_pk_bf16_f32 v204, v196, v197
    v_cvt_pk_bf16_f32 v205, v198, v199
    s_waitcnt lgkmcnt(7)
    v_mfma_f32_32x32x16_bf16 v[40:55], v[132:135], a[156:159], v[40:55]
    ds_read_b128 v[164:167], v7 offset:44032
    v_cvt_pk_bf16_f32 v206, v200, v201
    v_cvt_pk_bf16_f32 v207, v202, v203
    buffer_store_dwordx4 v[204:207], v6, s[20:23], s33 offen offset:512
    s_waitcnt lgkmcnt(7)
    v_mfma_f32_32x32x16_bf16 v[56:71], v[136:139], a[112:115], v[56:71]
    ds_read_b128 v[168:171], v209 offset:12288
    s_waitcnt lgkmcnt(7)
    v_mfma_f32_32x32x16_bf16 v[56:71], v[140:143], a[116:119], v[56:71]
    ds_read_b128 v[172:175], v209 offset:13312
    s_nop 1
    v_pk_mul_f32 v[184:185], v[40:41], s[34:35]
    v_pk_mul_f32 v[186:187], v[42:43], s[34:35]
    v_pk_mul_f32 v[188:189], v[44:45], s[34:35]
    s_waitcnt lgkmcnt(7)
    v_mfma_f32_32x32x16_bf16 v[56:71], v[144:147], a[120:123], v[56:71]
    ds_read_b128 v[176:179], v209 offset:14336
    v_pk_mul_f32 v[190:191], v[46:47], s[34:35]
    v_exp_f32 v184, v184
    v_exp_f32 v185, v185
    s_waitcnt lgkmcnt(7)
    v_mfma_f32_32x32x16_bf16 v[56:71], v[148:151], a[124:127], v[56:71]
    ds_read_b128 v[180:183], v209 offset:15360
    v_exp_f32 v186, v186
    v_exp_f32 v187, v187
    v_exp_f32 v188, v188
    s_waitcnt lgkmcnt(7)
    v_mfma_f32_32x32x16_bf16 v[56:71], v[152:155], a[128:131], v[56:71]
    ds_read_b128 v[120:123], v7 offset:16384
    v_exp_f32 v189, v189
    v_exp_f32 v190, v190
    v_exp_f32 v191, v191
    s_waitcnt lgkmcnt(7)
    v_mfma_f32_32x32x16_bf16 v[56:71], v[156:159], a[132:135], v[56:71]
    ds_read_b128 v[124:127], v7 offset:17408
    v_pk_add_f32 v[184:185], v[184:185], s[36:37]
    v_pk_add_f32 v[186:187], v[186:187], s[36:37]
    v_pk_add_f32 v[188:189], v[188:189], s[36:37]
    s_waitcnt lgkmcnt(7)
    v_mfma_f32_32x32x16_bf16 v[56:71], v[160:163], a[136:139], v[56:71]
    ds_read_b128 v[128:131], v7 offset:18432
    v_pk_add_f32 v[190:191], v[190:191], s[36:37]
    v_rcp_f32 v184, v184
    v_rcp_f32 v185, v185
    s_waitcnt lgkmcnt(7)
    v_mfma_f32_32x32x16_bf16 v[56:71], v[164:167], a[140:143], v[56:71]
    ds_read_b128 v[132:135], v7 offset:19456
    v_rcp_f32 v186, v186
    v_rcp_f32 v187, v187
    v_rcp_f32 v188, v188
    s_waitcnt lgkmcnt(7)
    v_mfma_f32_32x32x16_bf16 v[56:71], v[168:171], a[144:147], v[56:71]
    ds_read_b128 v[136:139], v7 offset:45056
    v_rcp_f32 v189, v189
    v_rcp_f32 v190, v190
    v_rcp_f32 v191, v191
    s_waitcnt lgkmcnt(7)
    v_mfma_f32_32x32x16_bf16 v[56:71], v[172:175], a[148:151], v[56:71]
    ds_read_b128 v[140:143], v7 offset:46080
    v_pk_mul_f32 v[184:185], v[184:185], v[48:49]
    v_pk_mul_f32 v[186:187], v[186:187], v[50:51]
    v_pk_mul_f32 v[188:189], v[188:189], v[52:53]
    s_waitcnt lgkmcnt(7)
    v_mfma_f32_32x32x16_bf16 v[56:71], v[176:179], a[152:155], v[56:71]
    ds_read_b128 v[144:147], v7 offset:47104
    v_pk_mul_f32 v[190:191], v[190:191], v[54:55]
    v_cvt_pk_bf16_f32 v192, v184, v185
    v_cvt_pk_bf16_f32 v193, v186, v187
    s_waitcnt lgkmcnt(7)
    v_mfma_f32_32x32x16_bf16 v[56:71], v[180:183], a[156:159], v[56:71]
    ds_read_b128 v[148:151], v7 offset:48128
    v_cvt_pk_bf16_f32 v194, v188, v189
    v_cvt_pk_bf16_f32 v195, v190, v191
    buffer_store_dwordx4 v[192:195], v6, s[20:23], s33 offen offset:1024
    s_waitcnt lgkmcnt(7)
    v_mfma_f32_32x32x16_bf16 v[72:87], v[120:123], a[112:115], v[72:87]
    ds_read_b128 v[152:155], v209 offset:16384
    s_waitcnt lgkmcnt(7)
    v_mfma_f32_32x32x16_bf16 v[72:87], v[124:127], a[116:119], v[72:87]
    ds_read_b128 v[156:159], v209 offset:17408
    s_nop 1
    v_pk_mul_f32 v[196:197], v[56:57], s[34:35]
    v_pk_mul_f32 v[198:199], v[58:59], s[34:35]
    v_pk_mul_f32 v[200:201], v[60:61], s[34:35]
    s_waitcnt lgkmcnt(7)
    v_mfma_f32_32x32x16_bf16 v[72:87], v[128:131], a[120:123], v[72:87]
    ds_read_b128 v[160:163], v209 offset:18432
    v_pk_mul_f32 v[202:203], v[62:63], s[34:35]
    v_exp_f32 v196, v196
    v_exp_f32 v197, v197
    s_waitcnt lgkmcnt(7)
    v_mfma_f32_32x32x16_bf16 v[72:87], v[132:135], a[124:127], v[72:87]
    ds_read_b128 v[164:167], v209 offset:19456
    v_exp_f32 v198, v198
    v_exp_f32 v199, v199
    v_exp_f32 v200, v200
    s_waitcnt lgkmcnt(7)
    v_mfma_f32_32x32x16_bf16 v[72:87], v[136:139], a[128:131], v[72:87]
    ds_read_b128 v[168:171], v7 offset:20480
    v_exp_f32 v201, v201
    v_exp_f32 v202, v202
    v_exp_f32 v203, v203
    s_waitcnt lgkmcnt(7)
    v_mfma_f32_32x32x16_bf16 v[72:87], v[140:143], a[132:135], v[72:87]
    ds_read_b128 v[172:175], v7 offset:21504
    v_pk_add_f32 v[196:197], v[196:197], s[36:37]
    v_pk_add_f32 v[198:199], v[198:199], s[36:37]
    v_pk_add_f32 v[200:201], v[200:201], s[36:37]
    s_waitcnt lgkmcnt(7)
    v_mfma_f32_32x32x16_bf16 v[72:87], v[144:147], a[136:139], v[72:87]
    ds_read_b128 v[176:179], v7 offset:22528
    v_pk_add_f32 v[202:203], v[202:203], s[36:37]
    v_rcp_f32 v196, v196
    v_rcp_f32 v197, v197
    s_waitcnt lgkmcnt(7)
    v_mfma_f32_32x32x16_bf16 v[72:87], v[148:151], a[140:143], v[72:87]
    ds_read_b128 v[180:183], v7 offset:23552
    v_rcp_f32 v198, v198
    v_rcp_f32 v199, v199
    v_rcp_f32 v200, v200
    s_waitcnt lgkmcnt(7)
    v_mfma_f32_32x32x16_bf16 v[72:87], v[152:155], a[144:147], v[72:87]
    ds_read_b128 v[120:123], v7 offset:49152
    v_rcp_f32 v201, v201
    v_rcp_f32 v202, v202
    v_rcp_f32 v203, v203
    s_waitcnt lgkmcnt(7)
    v_mfma_f32_32x32x16_bf16 v[72:87], v[156:159], a[148:151], v[72:87]
    ds_read_b128 v[124:127], v7 offset:50176
    v_pk_mul_f32 v[196:197], v[196:197], v[64:65]
    v_pk_mul_f32 v[198:199], v[198:199], v[66:67]
    v_pk_mul_f32 v[200:201], v[200:201], v[68:69]
    s_waitcnt lgkmcnt(7)
    v_mfma_f32_32x32x16_bf16 v[72:87], v[160:163], a[152:155], v[72:87]
    ds_read_b128 v[128:131], v7 offset:51200
    v_pk_mul_f32 v[202:203], v[202:203], v[70:71]
    v_cvt_pk_bf16_f32 v204, v196, v197
    v_cvt_pk_bf16_f32 v205, v198, v199
    s_waitcnt lgkmcnt(7)
    v_mfma_f32_32x32x16_bf16 v[72:87], v[164:167], a[156:159], v[72:87]
    ds_read_b128 v[132:135], v7 offset:52224
    v_cvt_pk_bf16_f32 v206, v200, v201
    v_cvt_pk_bf16_f32 v207, v202, v203
    buffer_store_dwordx4 v[204:207], v6, s[20:23], s33 offen offset:1536
    s_waitcnt lgkmcnt(7)
    v_mfma_f32_32x32x16_bf16 v[88:103], v[168:171], a[112:115], v[88:103]
    ds_read_b128 v[136:139], v209 offset:20480
    s_waitcnt lgkmcnt(7)
    v_mfma_f32_32x32x16_bf16 v[88:103], v[172:175], a[116:119], v[88:103]
    ds_read_b128 v[140:143], v209 offset:21504
    s_nop 1
    v_pk_mul_f32 v[184:185], v[72:73], s[34:35]
    v_pk_mul_f32 v[186:187], v[74:75], s[34:35]
    v_pk_mul_f32 v[188:189], v[76:77], s[34:35]
    s_waitcnt lgkmcnt(7)
    v_mfma_f32_32x32x16_bf16 v[88:103], v[176:179], a[120:123], v[88:103]
    ds_read_b128 v[144:147], v209 offset:22528
    v_pk_mul_f32 v[190:191], v[78:79], s[34:35]
    v_exp_f32 v184, v184
    v_exp_f32 v185, v185
    s_waitcnt lgkmcnt(7)
    v_mfma_f32_32x32x16_bf16 v[88:103], v[180:183], a[124:127], v[88:103]
    ds_read_b128 v[148:151], v209 offset:23552
    v_exp_f32 v186, v186
    v_exp_f32 v187, v187
    v_exp_f32 v188, v188
    s_waitcnt lgkmcnt(7)
    v_mfma_f32_32x32x16_bf16 v[88:103], v[120:123], a[128:131], v[88:103]
    ds_read_b128 v[152:155], v7 offset:24576
    v_exp_f32 v189, v189
    v_exp_f32 v190, v190
    v_exp_f32 v191, v191
    s_waitcnt lgkmcnt(7)
    v_mfma_f32_32x32x16_bf16 v[88:103], v[124:127], a[132:135], v[88:103]
    ds_read_b128 v[156:159], v7 offset:25600
    v_pk_add_f32 v[184:185], v[184:185], s[36:37]
    v_pk_add_f32 v[186:187], v[186:187], s[36:37]
    v_pk_add_f32 v[188:189], v[188:189], s[36:37]
    s_waitcnt lgkmcnt(7)
    v_mfma_f32_32x32x16_bf16 v[88:103], v[128:131], a[136:139], v[88:103]
    ds_read_b128 v[160:163], v7 offset:26624
    v_pk_add_f32 v[190:191], v[190:191], s[36:37]
    v_rcp_f32 v184, v184
    v_rcp_f32 v185, v185
    s_waitcnt lgkmcnt(7)
    v_mfma_f32_32x32x16_bf16 v[88:103], v[132:135], a[140:143], v[88:103]
    ds_read_b128 v[164:167], v7 offset:27648
    v_rcp_f32 v186, v186
    v_rcp_f32 v187, v187
    v_rcp_f32 v188, v188
    s_waitcnt lgkmcnt(7)
    v_mfma_f32_32x32x16_bf16 v[88:103], v[136:139], a[144:147], v[88:103]
    ds_read_b128 v[168:171], v7 offset:53248
    v_rcp_f32 v189, v189
    v_rcp_f32 v190, v190
    v_rcp_f32 v191, v191
    s_waitcnt lgkmcnt(7)
    v_mfma_f32_32x32x16_bf16 v[88:103], v[140:143], a[148:151], v[88:103]
    ds_read_b128 v[172:175], v7 offset:54272
    v_pk_mul_f32 v[184:185], v[184:185], v[80:81]
    v_pk_mul_f32 v[186:187], v[186:187], v[82:83]
    v_pk_mul_f32 v[188:189], v[188:189], v[84:85]
    s_waitcnt lgkmcnt(7)
    v_mfma_f32_32x32x16_bf16 v[88:103], v[144:147], a[152:155], v[88:103]
    ds_read_b128 v[176:179], v7 offset:55296
    v_pk_mul_f32 v[190:191], v[190:191], v[86:87]
    v_cvt_pk_bf16_f32 v192, v184, v185
    v_cvt_pk_bf16_f32 v193, v186, v187
    s_waitcnt lgkmcnt(7)
    v_mfma_f32_32x32x16_bf16 v[88:103], v[148:151], a[156:159], v[88:103]
    ds_read_b128 v[180:183], v7 offset:56320
    v_cvt_pk_bf16_f32 v194, v188, v189
    v_cvt_pk_bf16_f32 v195, v190, v191
    buffer_store_dwordx4 v[192:195], v6, s[20:23], s33 offen offset:2048
    s_waitcnt lgkmcnt(7)
    v_mfma_f32_32x32x16_bf16 v[104:119], v[152:155], a[112:115], v[104:119]
    ds_read_b128 v[120:123], v209 offset:24576
    s_waitcnt lgkmcnt(7)
    v_mfma_f32_32x32x16_bf16 v[104:119], v[156:159], a[116:119], v[104:119]
    ds_read_b128 v[124:127], v209 offset:25600
    s_nop 1
    v_pk_mul_f32 v[196:197], v[88:89], s[34:35]
    v_pk_mul_f32 v[198:199], v[90:91], s[34:35]
    v_pk_mul_f32 v[200:201], v[92:93], s[34:35]
    s_waitcnt lgkmcnt(7)
    v_mfma_f32_32x32x16_bf16 v[104:119], v[160:163], a[120:123], v[104:119]
    ds_read_b128 v[128:131], v209 offset:26624
    v_pk_mul_f32 v[202:203], v[94:95], s[34:35]
    v_exp_f32 v196, v196
    v_exp_f32 v197, v197
    s_waitcnt lgkmcnt(7)
    v_mfma_f32_32x32x16_bf16 v[104:119], v[164:167], a[124:127], v[104:119]
    ds_read_b128 v[132:135], v209 offset:27648
    v_exp_f32 v198, v198
    v_exp_f32 v199, v199
    v_exp_f32 v200, v200
    s_waitcnt lgkmcnt(7)
    v_mfma_f32_32x32x16_bf16 v[104:119], v[168:171], a[128:131], v[104:119]
    v_exp_f32 v201, v201
    v_exp_f32 v202, v202
    v_exp_f32 v203, v203
    s_waitcnt lgkmcnt(6)
    v_mfma_f32_32x32x16_bf16 v[104:119], v[172:175], a[132:135], v[104:119]
    v_pk_add_f32 v[196:197], v[196:197], s[36:37]
    v_pk_add_f32 v[198:199], v[198:199], s[36:37]
    v_pk_add_f32 v[200:201], v[200:201], s[36:37]
    s_waitcnt lgkmcnt(5)
    v_mfma_f32_32x32x16_bf16 v[104:119], v[176:179], a[136:139], v[104:119]
    v_pk_add_f32 v[202:203], v[202:203], s[36:37]
    v_rcp_f32 v196, v196
    v_rcp_f32 v197, v197
    s_waitcnt lgkmcnt(4)
    v_mfma_f32_32x32x16_bf16 v[104:119], v[180:183], a[140:143], v[104:119]
    v_rcp_f32 v198, v198
    v_rcp_f32 v199, v199
    v_rcp_f32 v200, v200
    s_waitcnt lgkmcnt(3)
    v_mfma_f32_32x32x16_bf16 v[104:119], v[120:123], a[144:147], v[104:119]
    v_rcp_f32 v201, v201
    v_rcp_f32 v202, v202
    v_rcp_f32 v203, v203
    s_waitcnt lgkmcnt(2)
    v_mfma_f32_32x32x16_bf16 v[104:119], v[124:127], a[148:151], v[104:119]
    v_pk_mul_f32 v[196:197], v[196:197], v[96:97]
    v_pk_mul_f32 v[198:199], v[198:199], v[98:99]
    v_pk_mul_f32 v[200:201], v[200:201], v[100:101]
    s_waitcnt lgkmcnt(1)
    v_mfma_f32_32x32x16_bf16 v[104:119], v[128:131], a[152:155], v[104:119]
    v_pk_mul_f32 v[202:203], v[202:203], v[102:103]
    v_cvt_pk_bf16_f32 v204, v196, v197
    v_cvt_pk_bf16_f32 v205, v198, v199
    s_waitcnt lgkmcnt(0)
    v_mfma_f32_32x32x16_bf16 v[104:119], v[132:135], a[156:159], v[104:119]
    v_cvt_pk_bf16_f32 v206, v200, v201
    v_cvt_pk_bf16_f32 v207, v202, v203
    buffer_store_dwordx4 v[204:207], v6, s[20:23], s33 offen offset:2560
    s_nop 8
    v_pk_mul_f32 v[184:185], v[104:105], s[34:35]
    v_pk_mul_f32 v[186:187], v[106:107], s[34:35]
    v_pk_mul_f32 v[188:189], v[108:109], s[34:35]
    v_pk_mul_f32 v[190:191], v[110:111], s[34:35]
    v_exp_f32 v184, v184
    v_exp_f32 v185, v185
    v_exp_f32 v186, v186
    v_exp_f32 v187, v187
    v_exp_f32 v188, v188
    v_exp_f32 v189, v189
    v_exp_f32 v190, v190
    v_exp_f32 v191, v191
    v_pk_add_f32 v[184:185], v[184:185], s[36:37]
    v_pk_add_f32 v[186:187], v[186:187], s[36:37]
    v_pk_add_f32 v[188:189], v[188:189], s[36:37]
    v_pk_add_f32 v[190:191], v[190:191], s[36:37]
    v_rcp_f32 v184, v184
    v_rcp_f32 v185, v185
    v_rcp_f32 v186, v186
    v_rcp_f32 v187, v187
    v_rcp_f32 v188, v188
    v_rcp_f32 v189, v189
    v_rcp_f32 v190, v190
    v_rcp_f32 v191, v191
    v_pk_mul_f32 v[184:185], v[184:185], v[112:113]
    v_pk_mul_f32 v[186:187], v[186:187], v[114:115]
    v_pk_mul_f32 v[188:189], v[188:189], v[116:117]
    v_pk_mul_f32 v[190:191], v[190:191], v[118:119]
    v_cvt_pk_bf16_f32 v192, v184, v185
    v_cvt_pk_bf16_f32 v193, v186, v187
    v_cvt_pk_bf16_f32 v194, v188, v189
    v_cvt_pk_bf16_f32 v195, v190, v191
    buffer_store_dwordx4 v[192:195], v6, s[20:23], s33 offen offset:3072
L_kc_end:
    s_endpgm
.globl kd_kernel
.p2align 8
.type kd_kernel,@function
kd_kernel:

    s_cmp_ge_u32 s2, 256
    s_cbranch_scc1 L_kd_end
    s_load_dwordx2 s[4:5], s[0:1], 88
    s_load_dwordx2 s[36:37], s[0:1], 72
    v_lshrrev_b32 v1, 6, v0
    v_and_b32 v2, 63, v0
    v_readfirstlane_b32 s6, v1
    v_lshlrev_b32 v3, 4, v2
    s_and_b32 s7, s2, 7
    s_lshr_b32 s8, s2, 3
    s_and_b32 s9, s7, 3
    s_lshl_b32 s9, s9, 3
    s_and_b32 s10, s8, 7
    s_add_u32 s9, s9, s10
    s_lshr_b32 s10, s7, 2
    s_lshl_b32 s10, s10, 2
    s_lshr_b32 s11, s8, 3
    s_add_u32 s10, s10, s11
    s_mul_i32 s11, s6, 14
    s_cmp_eq_u32 s6, 3
    s_cselect_b32 s32, 1, 0
    s_sub_u32 s11, s11, s32
    s_lshl_b32 s11, s11, 10
    s_waitcnt lgkmcnt(0)
    s_add_u32 s12, s4, 12320768
    s_addc_u32 s13, s5, 0
    s_mov_b32 s14, 2211840
    s_mov_b32 s15, 0x00020000
    s_add_u32 s16, s4, 14680064
    s_addc_u32 s17, s5, 0
    s_mov_b32 s18, 7077888
    s_mov_b32 s19, 0x00020000
    s_add_u32 s20, s4, 2621440
    s_addc_u32 s21, s5, 0
    s_mov_b32 s22, 2621440
    s_mov_b32 s23, 0x00020000
    s_mov_b32 s24, s36
    s_mov_b32 s25, s37
    s_mov_b32 s26, 2621440
    s_mov_b32 s27, 0x00020000
    s_mul_i32 s28, s10, 276480
    s_mul_i32 s29, s9, 221184
    v_add_u32 v4, s28, v3
    s_add_u32 s28, s28, 55296
    v_add_u32 v5, s28, v3
    s_add_u32 s28, s28, 55296
    v_add_u32 v6, s28, v3
    s_add_u32 s28, s28, 55296
    v_add_u32 v7, s28, v3
    s_add_u32 s28, s28, 55296
    v_add_u32 v8, s28, v3
    s_add_u32 s30, s6, 0
    s_and_b32 s30, s30, 3
    s_mul_i32 s30, s30, 55296
    s_add_u32 s30, s30, s29
    v_add_u32 v9, s30, v3
    s_add_u32 s30, s6, 1
    s_and_b32 s30, s30, 3
    s_mul_i32 s30, s30, 55296
    s_add_u32 s30, s30, s29
    v_add_u32 v10, s30, v3
    s_add_u32 s30, s6, 2
    s_and_b32 s30, s30, 3
    s_mul_i32 s30, s30, 55296
    s_add_u32 s30, s30, s29
    v_add_u32 v11, s30, v3
    s_add_u32 s30, s6, 3
    s_and_b32 s30, s30, 3
    s_mul_i32 s30, s30, 55296
    s_add_u32 s30, s30, s29
    v_add_u32 v12, s30, v3
    buffer_load_dwordx4 v[96:99], v4, s[12:15], s11 offen offset:0
    buffer_load_dwordx4 v[100:103], v5, s[12:15], s11 offen offset:0
    buffer_load_dwordx4 v[104:107], v6, s[12:15], s11 offen offset:0
    buffer_load_dwordx4 v[108:111], v7, s[12:15], s11 offen offset:0
    buffer_load_dwordx4 v[112:115], v8, s[12:15], s11 offen offset:0
    buffer_load_dwordx4 v[116:119], v9, s[16:19], s11 offen offset:0
    buffer_load_dwordx4 v[120:123], v10, s[16:19], s11 offen offset:0
    buffer_load_dwordx4 v[124:127], v11, s[16:19], s11 offen offset:0
    buffer_load_dwordx4 v[128:131], v12, s[16:19], s11 offen offset:0
    buffer_load_dwordx4 v[132:135], v4, s[12:15], s11 offen offset:1024
    buffer_load_dwordx4 v[136:139], v5, s[12:15], s11 offen offset:1024
    buffer_load_dwordx4 v[140:143], v6, s[12:15], s11 offen offset:1024
    buffer_load_dwordx4 v[144:147], v7, s[12:15], s11 offen offset:1024
    buffer_load_dwordx4 v[148:151], v8, s[12:15], s11 offen offset:1024
    buffer_load_dwordx4 v[152:155], v9, s[16:19], s11 offen offset:1024
    buffer_load_dwordx4 v[156:159], v10, s[16:19], s11 offen offset:1024
    buffer_load_dwordx4 v[160:163], v11, s[16:19], s11 offen offset:1024
    buffer_load_dwordx4 v[164:167], v12, s[16:19], s11 offen offset:1024
    buffer_load_dwordx4 v[168:171], v4, s[12:15], s11 offen offset:2048
    buffer_load_dwordx4 v[172:175], v5, s[12:15], s11 offen offset:2048
    buffer_load_dwordx4 v[176:179], v6, s[12:15], s11 offen offset:2048
    buffer_load_dwordx4 v[180:183], v7, s[12:15], s11 offen offset:2048
    buffer_load_dwordx4 v[184:187], v8, s[12:15], s11 offen offset:2048
    buffer_load_dwordx4 v[188:191], v9, s[16:19], s11 offen offset:2048
    buffer_load_dwordx4 v[192:195], v10, s[16:19], s11 offen offset:2048
    buffer_load_dwordx4 v[196:199], v11, s[16:19], s11 offen offset:2048
    buffer_load_dwordx4 v[200:203], v12, s[16:19], s11 offen offset:2048
    v_mov_b32 v16, 0
    v_mov_b32 v17, 0
    v_mov_b32 v18, 0
    v_mov_b32 v19, 0
    v_mov_b32 v20, 0
    v_mov_b32 v21, 0
    v_mov_b32 v22, 0
    v_mov_b32 v23, 0
    v_mov_b32 v24, 0
    v_mov_b32 v25, 0
    v_mov_b32 v26, 0
    v_mov_b32 v27, 0
    v_mov_b32 v28, 0
    v_mov_b32 v29, 0
    v_mov_b32 v30, 0
    v_mov_b32 v31, 0
    v_mov_b32 v32, 0
    v_mov_b32 v33, 0
    v_mov_b32 v34, 0
    v_mov_b32 v35, 0
    v_mov_b32 v36, 0
    v_mov_b32 v37, 0
    v_mov_b32 v38, 0
    v_mov_b32 v39, 0
    v_mov_b32 v40, 0
    v_mov_b32 v41, 0
    v_mov_b32 v42, 0
    v_mov_b32 v43, 0
    v_mov_b32 v44, 0
    v_mov_b32 v45, 0
    v_mov_b32 v46, 0
    v_mov_b32 v47, 0
    v_mov_b32 v48, 0
    v_mov_b32 v49, 0
    v_mov_b32 v50, 0
    v_mov_b32 v51, 0
    v_mov_b32 v52, 0
    v_mov_b32 v53, 0
    v_mov_b32 v54, 0
    v_mov_b32 v55, 0
    v_mov_b32 v56, 0
    v_mov_b32 v57, 0
    v_mov_b32 v58, 0
    v_mov_b32 v59, 0
    v_mov_b32 v60, 0
    v_mov_b32 v61, 0
    v_mov_b32 v62, 0
    v_mov_b32 v63, 0
    v_mov_b32 v64, 0
    v_mov_b32 v65, 0
    v_mov_b32 v66, 0
    v_mov_b32 v67, 0
    v_mov_b32 v68, 0
    v_mov_b32 v69, 0
    v_mov_b32 v70, 0
    v_mov_b32 v71, 0
    v_mov_b32 v72, 0
    v_mov_b32 v73, 0
    v_mov_b32 v74, 0
    v_mov_b32 v75, 0
    v_mov_b32 v76, 0
    v_mov_b32 v77, 0
    v_mov_b32 v78, 0
    v_mov_b32 v79, 0
    v_mov_b32 v80, 0
    v_mov_b32 v81, 0
    v_mov_b32 v82, 0
    v_mov_b32 v83, 0
    v_mov_b32 v84, 0
    v_mov_b32 v85, 0
    v_mov_b32 v86, 0
    v_mov_b32 v87, 0
    v_mov_b32 v88, 0
    v_mov_b32 v89, 0
    v_mov_b32 v90, 0
    v_mov_b32 v91, 0
    v_mov_b32 v92, 0
    v_mov_b32 v93, 0
    v_mov_b32 v94, 0
    v_mov_b32 v95, 0
    v_and_b32 v13, 15, v2
    s_lshl_b32 s30, s9, 6
    s_lshl_b32 s31, s6, 4
    s_add_u32 s30, s30, s31
    v_add_u32 v13, s30, v13
    v_mul_u32_u24 v13, 1280, v13
    v_lshrrev_b32 v14, 4, v2
    v_lshlrev_b32 v14, 3, v14
    s_mul_i32 s31, s10, 160
    v_add3_u32 v13, v13, v14, s31
    s_waitcnt vmcnt(18)
    v_mfma_f32_16x16x32_bf16 v[16:19], v[96:99], v[116:119], v[16:19]
    buffer_load_dwordx4 v[204:207], v4, s[12:15], s11 offen offset:3072
    v_mfma_f32_16x16x32_bf16 v[20:23], v[96:99], v[120:123], v[20:23]
    v_mfma_f32_16x16x32_bf16 v[24:27], v[96:99], v[124:127], v[24:27]
    buffer_load_dwordx4 v[208:211], v5, s[12:15], s11 offen offset:3072
    v_mfma_f32_16x16x32_bf16 v[28:31], v[96:99], v[128:131], v[28:31]
    v_mfma_f32_16x16x32_bf16 v[32:35], v[100:103], v[116:119], v[32:35]
    buffer_load_dwordx4 v[212:215], v6, s[12:15], s11 offen offset:3072
    v_mfma_f32_16x16x32_bf16 v[36:39], v[100:103], v[120:123], v[36:39]
    v_mfma_f32_16x16x32_bf16 v[40:43], v[100:103], v[124:127], v[40:43]
    buffer_load_dwordx4 v[216:219], v7, s[12:15], s11 offen offset:3072
    v_mfma_f32_16x16x32_bf16 v[44:47], v[100:103], v[128:131], v[44:47]
    v_mfma_f32_16x16x32_bf16 v[48:51], v[104:107], v[116:119], v[48:51]
    buffer_load_dwordx4 v[220:223], v8, s[12:15], s11 offen offset:3072
    v_mfma_f32_16x16x32_bf16 v[52:55], v[104:107], v[120:123], v[52:55]
    v_mfma_f32_16x16x32_bf16 v[56:59], v[104:107], v[124:127], v[56:59]
    buffer_load_dwordx4 v[224:227], v9, s[16:19], s11 offen offset:3072
    v_mfma_f32_16x16x32_bf16 v[60:63], v[104:107], v[128:131], v[60:63]
    v_mfma_f32_16x16x32_bf16 v[64:67], v[108:111], v[116:119], v[64:67]
    buffer_load_dwordx4 v[228:231], v10, s[16:19], s11 offen offset:3072
    v_mfma_f32_16x16x32_bf16 v[68:71], v[108:111], v[120:123], v[68:71]
    v_mfma_f32_16x16x32_bf16 v[72:75], v[108:111], v[124:127], v[72:75]
    buffer_load_dwordx4 v[232:235], v11, s[16:19], s11 offen offset:3072
    v_mfma_f32_16x16x32_bf16 v[76:79], v[108:111], v[128:131], v[76:79]
    v_mfma_f32_16x16x32_bf16 v[80:83], v[112:115], v[116:119], v[80:83]
    buffer_load_dwordx4 v[236:239], v12, s[16:19], s11 offen offset:3072
    v_mfma_f32_16x16x32_bf16 v[84:87], v[112:115], v[120:123], v[84:87]
    v_mfma_f32_16x16x32_bf16 v[88:91], v[112:115], v[124:127], v[88:91]
    v_mfma_f32_16x16x32_bf16 v[92:95], v[112:115], v[128:131], v[92:95]
    s_waitcnt vmcnt(18)
    v_mfma_f32_16x16x32_bf16 v[16:19], v[132:135], v[152:155], v[16:19]
    s_add_u32 s11, s11, 4096
    buffer_load_dwordx4 v[96:99], v4, s[12:15], s11 offen offset:0
    v_mfma_f32_16x16x32_bf16 v[20:23], v[132:135], v[156:159], v[20:23]
    v_mfma_f32_16x16x32_bf16 v[24:27], v[132:135], v[160:163], v[24:27]
    buffer_load_dwordx4 v[100:103], v5, s[12:15], s11 offen offset:0
    v_mfma_f32_16x16x32_bf16 v[28:31], v[132:135], v[164:167], v[28:31]
    v_mfma_f32_16x16x32_bf16 v[32:35], v[136:139], v[152:155], v[32:35]
    buffer_load_dwordx4 v[104:107], v6, s[12:15], s11 offen offset:0
    v_mfma_f32_16x16x32_bf16 v[36:39], v[136:139], v[156:159], v[36:39]
    v_mfma_f32_16x16x32_bf16 v[40:43], v[136:139], v[160:163], v[40:43]
    buffer_load_dwordx4 v[108:111], v7, s[12:15], s11 offen offset:0
    v_mfma_f32_16x16x32_bf16 v[44:47], v[136:139], v[164:167], v[44:47]
    v_mfma_f32_16x16x32_bf16 v[48:51], v[140:143], v[152:155], v[48:51]
    buffer_load_dwordx4 v[112:115], v8, s[12:15], s11 offen offset:0
    v_mfma_f32_16x16x32_bf16 v[52:55], v[140:143], v[156:159], v[52:55]
    v_mfma_f32_16x16x32_bf16 v[56:59], v[140:143], v[160:163], v[56:59]
    buffer_load_dwordx4 v[116:119], v9, s[16:19], s11 offen offset:0
    v_mfma_f32_16x16x32_bf16 v[60:63], v[140:143], v[164:167], v[60:63]
    v_mfma_f32_16x16x32_bf16 v[64:67], v[144:147], v[152:155], v[64:67]
    buffer_load_dwordx4 v[120:123], v10, s[16:19], s11 offen offset:0
    v_mfma_f32_16x16x32_bf16 v[68:71], v[144:147], v[156:159], v[68:71]
    v_mfma_f32_16x16x32_bf16 v[72:75], v[144:147], v[160:163], v[72:75]
    buffer_load_dwordx4 v[124:127], v11, s[16:19], s11 offen offset:0
    v_mfma_f32_16x16x32_bf16 v[76:79], v[144:147], v[164:167], v[76:79]
    v_mfma_f32_16x16x32_bf16 v[80:83], v[148:151], v[152:155], v[80:83]
    buffer_load_dwordx4 v[128:131], v12, s[16:19], s11 offen offset:0
    v_mfma_f32_16x16x32_bf16 v[84:87], v[148:151], v[156:159], v[84:87]
    v_mfma_f32_16x16x32_bf16 v[88:91], v[148:151], v[160:163], v[88:91]
    v_mfma_f32_16x16x32_bf16 v[92:95], v[148:151], v[164:167], v[92:95]
    s_waitcnt vmcnt(18)
    v_mfma_f32_16x16x32_bf16 v[16:19], v[168:171], v[188:191], v[16:19]
    buffer_load_dwordx4 v[132:135], v4, s[12:15], s11 offen offset:1024
    v_mfma_f32_16x16x32_bf16 v[20:23], v[168:171], v[192:195], v[20:23]
    v_mfma_f32_16x16x32_bf16 v[24:27], v[168:171], v[196:199], v[24:27]
    buffer_load_dwordx4 v[136:139], v5, s[12:15], s11 offen offset:1024
    v_mfma_f32_16x16x32_bf16 v[28:31], v[168:171], v[200:203], v[28:31]
    v_mfma_f32_16x16x32_bf16 v[32:35], v[172:175], v[188:191], v[32:35]
    buffer_load_dwordx4 v[140:143], v6, s[12:15], s11 offen offset:1024
    v_mfma_f32_16x16x32_bf16 v[36:39], v[172:175], v[192:195], v[36:39]
    v_mfma_f32_16x16x32_bf16 v[40:43], v[172:175], v[196:199], v[40:43]
    buffer_load_dwordx4 v[144:147], v7, s[12:15], s11 offen offset:1024
    v_mfma_f32_16x16x32_bf16 v[44:47], v[172:175], v[200:203], v[44:47]
    v_mfma_f32_16x16x32_bf16 v[48:51], v[176:179], v[188:191], v[48:51]
    buffer_load_dwordx4 v[148:151], v8, s[12:15], s11 offen offset:1024
    v_mfma_f32_16x16x32_bf16 v[52:55], v[176:179], v[192:195], v[52:55]
    v_mfma_f32_16x16x32_bf16 v[56:59], v[176:179], v[196:199], v[56:59]
    buffer_load_dwordx4 v[152:155], v9, s[16:19], s11 offen offset:1024
    v_mfma_f32_16x16x32_bf16 v[60:63], v[176:179], v[200:203], v[60:63]
    v_mfma_f32_16x16x32_bf16 v[64:67], v[180:183], v[188:191], v[64:67]
    buffer_load_dwordx4 v[156:159], v10, s[16:19], s11 offen offset:1024
    v_mfma_f32_16x16x32_bf16 v[68:71], v[180:183], v[192:195], v[68:71]
    v_mfma_f32_16x16x32_bf16 v[72:75], v[180:183], v[196:199], v[72:75]
    buffer_load_dwordx4 v[160:163], v11, s[16:19], s11 offen offset:1024
    v_mfma_f32_16x16x32_bf16 v[76:79], v[180:183], v[200:203], v[76:79]
    v_mfma_f32_16x16x32_bf16 v[80:83], v[184:187], v[188:191], v[80:83]
    buffer_load_dwordx4 v[164:167], v12, s[16:19], s11 offen offset:1024
    v_mfma_f32_16x16x32_bf16 v[84:87], v[184:187], v[192:195], v[84:87]
    v_mfma_f32_16x16x32_bf16 v[88:91], v[184:187], v[196:199], v[88:91]
    v_mfma_f32_16x16x32_bf16 v[92:95], v[184:187], v[200:203], v[92:95]
    s_waitcnt vmcnt(18)
    v_mfma_f32_16x16x32_bf16 v[16:19], v[204:207], v[224:227], v[16:19]
    buffer_load_dwordx4 v[168:171], v4, s[12:15], s11 offen offset:2048
    v_mfma_f32_16x16x32_bf16 v[20:23], v[204:207], v[228:231], v[20:23]
    v_mfma_f32_16x16x32_bf16 v[24:27], v[204:207], v[232:235], v[24:27]
    buffer_load_dwordx4 v[172:175], v5, s[12:15], s11 offen offset:2048
    v_mfma_f32_16x16x32_bf16 v[28:31], v[204:207], v[236:239], v[28:31]
    v_mfma_f32_16x16x32_bf16 v[32:35], v[208:211], v[224:227], v[32:35]
    buffer_load_dwordx4 v[176:179], v6, s[12:15], s11 offen offset:2048
    v_mfma_f32_16x16x32_bf16 v[36:39], v[208:211], v[228:231], v[36:39]
    v_mfma_f32_16x16x32_bf16 v[40:43], v[208:211], v[232:235], v[40:43]
    buffer_load_dwordx4 v[180:183], v7, s[12:15], s11 offen offset:2048
    v_mfma_f32_16x16x32_bf16 v[44:47], v[208:211], v[236:239], v[44:47]
    v_mfma_f32_16x16x32_bf16 v[48:51], v[212:215], v[224:227], v[48:51]
    buffer_load_dwordx4 v[184:187], v8, s[12:15], s11 offen offset:2048
    v_mfma_f32_16x16x32_bf16 v[52:55], v[212:215], v[228:231], v[52:55]
    v_mfma_f32_16x16x32_bf16 v[56:59], v[212:215], v[232:235], v[56:59]
    buffer_load_dwordx4 v[188:191], v9, s[16:19], s11 offen offset:2048
    v_mfma_f32_16x16x32_bf16 v[60:63], v[212:215], v[236:239], v[60:63]
    v_mfma_f32_16x16x32_bf16 v[64:67], v[216:219], v[224:227], v[64:67]
    buffer_load_dwordx4 v[192:195], v10, s[16:19], s11 offen offset:2048
    v_mfma_f32_16x16x32_bf16 v[68:71], v[216:219], v[228:231], v[68:71]
    v_mfma_f32_16x16x32_bf16 v[72:75], v[216:219], v[232:235], v[72:75]
    buffer_load_dwordx4 v[196:199], v11, s[16:19], s11 offen offset:2048
    v_mfma_f32_16x16x32_bf16 v[76:79], v[216:219], v[236:239], v[76:79]
    v_mfma_f32_16x16x32_bf16 v[80:83], v[220:223], v[224:227], v[80:83]
    buffer_load_dwordx4 v[200:203], v12, s[16:19], s11 offen offset:2048
    v_mfma_f32_16x16x32_bf16 v[84:87], v[220:223], v[228:231], v[84:87]
    v_mfma_f32_16x16x32_bf16 v[88:91], v[220:223], v[232:235], v[88:91]
    v_mfma_f32_16x16x32_bf16 v[92:95], v[220:223], v[236:239], v[92:95]
    s_waitcnt vmcnt(18)
    v_mfma_f32_16x16x32_bf16 v[16:19], v[96:99], v[116:119], v[16:19]
    buffer_load_dwordx4 v[204:207], v4, s[12:15], s11 offen offset:3072
    v_mfma_f32_16x16x32_bf16 v[20:23], v[96:99], v[120:123], v[20:23]
    v_mfma_f32_16x16x32_bf16 v[24:27], v[96:99], v[124:127], v[24:27]
    buffer_load_dwordx4 v[208:211], v5, s[12:15], s11 offen offset:3072
    v_mfma_f32_16x16x32_bf16 v[28:31], v[96:99], v[128:131], v[28:31]
    v_mfma_f32_16x16x32_bf16 v[32:35], v[100:103], v[116:119], v[32:35]
    buffer_load_dwordx4 v[212:215], v6, s[12:15], s11 offen offset:3072
    v_mfma_f32_16x16x32_bf16 v[36:39], v[100:103], v[120:123], v[36:39]
    v_mfma_f32_16x16x32_bf16 v[40:43], v[100:103], v[124:127], v[40:43]
    buffer_load_dwordx4 v[216:219], v7, s[12:15], s11 offen offset:3072
    v_mfma_f32_16x16x32_bf16 v[44:47], v[100:103], v[128:131], v[44:47]
    v_mfma_f32_16x16x32_bf16 v[48:51], v[104:107], v[116:119], v[48:51]
    buffer_load_dwordx4 v[220:223], v8, s[12:15], s11 offen offset:3072
    v_mfma_f32_16x16x32_bf16 v[52:55], v[104:107], v[120:123], v[52:55]
    v_mfma_f32_16x16x32_bf16 v[56:59], v[104:107], v[124:127], v[56:59]
    buffer_load_dwordx4 v[224:227], v9, s[16:19], s11 offen offset:3072
    v_mfma_f32_16x16x32_bf16 v[60:63], v[104:107], v[128:131], v[60:63]
    v_mfma_f32_16x16x32_bf16 v[64:67], v[108:111], v[116:119], v[64:67]
    buffer_load_dwordx4 v[228:231], v10, s[16:19], s11 offen offset:3072
    v_mfma_f32_16x16x32_bf16 v[68:71], v[108:111], v[120:123], v[68:71]
    v_mfma_f32_16x16x32_bf16 v[72:75], v[108:111], v[124:127], v[72:75]
    buffer_load_dwordx4 v[232:235], v11, s[16:19], s11 offen offset:3072
    v_mfma_f32_16x16x32_bf16 v[76:79], v[108:111], v[128:131], v[76:79]
    v_mfma_f32_16x16x32_bf16 v[80:83], v[112:115], v[116:119], v[80:83]
    buffer_load_dwordx4 v[236:239], v12, s[16:19], s11 offen offset:3072
    v_mfma_f32_16x16x32_bf16 v[84:87], v[112:115], v[120:123], v[84:87]
    v_mfma_f32_16x16x32_bf16 v[88:91], v[112:115], v[124:127], v[88:91]
    v_mfma_f32_16x16x32_bf16 v[92:95], v[112:115], v[128:131], v[92:95]
    s_waitcnt vmcnt(18)
    v_mfma_f32_16x16x32_bf16 v[16:19], v[132:135], v[152:155], v[16:19]
    s_add_u32 s11, s11, 4096
    buffer_load_dwordx4 v[96:99], v4, s[12:15], s11 offen offset:0
    v_mfma_f32_16x16x32_bf16 v[20:23], v[132:135], v[156:159], v[20:23]
    v_mfma_f32_16x16x32_bf16 v[24:27], v[132:135], v[160:163], v[24:27]
    buffer_load_dwordx4 v[100:103], v5, s[12:15], s11 offen offset:0
    v_mfma_f32_16x16x32_bf16 v[28:31], v[132:135], v[164:167], v[28:31]
    v_mfma_f32_16x16x32_bf16 v[32:35], v[136:139], v[152:155], v[32:35]
    buffer_load_dwordx4 v[104:107], v6, s[12:15], s11 offen offset:0
    v_mfma_f32_16x16x32_bf16 v[36:39], v[136:139], v[156:159], v[36:39]
    v_mfma_f32_16x16x32_bf16 v[40:43], v[136:139], v[160:163], v[40:43]
    buffer_load_dwordx4 v[108:111], v7, s[12:15], s11 offen offset:0
    v_mfma_f32_16x16x32_bf16 v[44:47], v[136:139], v[164:167], v[44:47]
    v_mfma_f32_16x16x32_bf16 v[48:51], v[140:143], v[152:155], v[48:51]
    buffer_load_dwordx4 v[112:115], v8, s[12:15], s11 offen offset:0
    v_mfma_f32_16x16x32_bf16 v[52:55], v[140:143], v[156:159], v[52:55]
    v_mfma_f32_16x16x32_bf16 v[56:59], v[140:143], v[160:163], v[56:59]
    buffer_load_dwordx4 v[116:119], v9, s[16:19], s11 offen offset:0
    v_mfma_f32_16x16x32_bf16 v[60:63], v[140:143], v[164:167], v[60:63]
    v_mfma_f32_16x16x32_bf16 v[64:67], v[144:147], v[152:155], v[64:67]
    buffer_load_dwordx4 v[120:123], v10, s[16:19], s11 offen offset:0
    v_mfma_f32_16x16x32_bf16 v[68:71], v[144:147], v[156:159], v[68:71]
    v_mfma_f32_16x16x32_bf16 v[72:75], v[144:147], v[160:163], v[72:75]
    buffer_load_dwordx4 v[124:127], v11, s[16:19], s11 offen offset:0
    v_mfma_f32_16x16x32_bf16 v[76:79], v[144:147], v[164:167], v[76:79]
    v_mfma_f32_16x16x32_bf16 v[80:83], v[148:151], v[152:155], v[80:83]
    buffer_load_dwordx4 v[128:131], v12, s[16:19], s11 offen offset:0
    v_mfma_f32_16x16x32_bf16 v[84:87], v[148:151], v[156:159], v[84:87]
    v_mfma_f32_16x16x32_bf16 v[88:91], v[148:151], v[160:163], v[88:91]
    v_mfma_f32_16x16x32_bf16 v[92:95], v[148:151], v[164:167], v[92:95]
    s_waitcnt vmcnt(18)
    v_mfma_f32_16x16x32_bf16 v[16:19], v[168:171], v[188:191], v[16:19]
    buffer_load_dwordx4 v[132:135], v4, s[12:15], s11 offen offset:1024
    v_mfma_f32_16x16x32_bf16 v[20:23], v[168:171], v[192:195], v[20:23]
    v_mfma_f32_16x16x32_bf16 v[24:27], v[168:171], v[196:199], v[24:27]
    buffer_load_dwordx4 v[136:139], v5, s[12:15], s11 offen offset:1024
    v_mfma_f32_16x16x32_bf16 v[28:31], v[168:171], v[200:203], v[28:31]
    v_mfma_f32_16x16x32_bf16 v[32:35], v[172:175], v[188:191], v[32:35]
    buffer_load_dwordx4 v[140:143], v6, s[12:15], s11 offen offset:1024
    v_mfma_f32_16x16x32_bf16 v[36:39], v[172:175], v[192:195], v[36:39]
    v_mfma_f32_16x16x32_bf16 v[40:43], v[172:175], v[196:199], v[40:43]
    buffer_load_dwordx4 v[144:147], v7, s[12:15], s11 offen offset:1024
    v_mfma_f32_16x16x32_bf16 v[44:47], v[172:175], v[200:203], v[44:47]
    v_mfma_f32_16x16x32_bf16 v[48:51], v[176:179], v[188:191], v[48:51]
    buffer_load_dwordx4 v[148:151], v8, s[12:15], s11 offen offset:1024
    v_mfma_f32_16x16x32_bf16 v[52:55], v[176:179], v[192:195], v[52:55]
    v_mfma_f32_16x16x32_bf16 v[56:59], v[176:179], v[196:199], v[56:59]
    buffer_load_dwordx4 v[152:155], v9, s[16:19], s11 offen offset:1024
    v_mfma_f32_16x16x32_bf16 v[60:63], v[176:179], v[200:203], v[60:63]
    v_mfma_f32_16x16x32_bf16 v[64:67], v[180:183], v[188:191], v[64:67]
    buffer_load_dwordx4 v[156:159], v10, s[16:19], s11 offen offset:1024
    v_mfma_f32_16x16x32_bf16 v[68:71], v[180:183], v[192:195], v[68:71]
    v_mfma_f32_16x16x32_bf16 v[72:75], v[180:183], v[196:199], v[72:75]
    buffer_load_dwordx4 v[160:163], v11, s[16:19], s11 offen offset:1024
    v_mfma_f32_16x16x32_bf16 v[76:79], v[180:183], v[200:203], v[76:79]
    v_mfma_f32_16x16x32_bf16 v[80:83], v[184:187], v[188:191], v[80:83]
    buffer_load_dwordx4 v[164:167], v12, s[16:19], s11 offen offset:1024
    v_mfma_f32_16x16x32_bf16 v[84:87], v[184:187], v[192:195], v[84:87]
    v_mfma_f32_16x16x32_bf16 v[88:91], v[184:187], v[196:199], v[88:91]
    v_mfma_f32_16x16x32_bf16 v[92:95], v[184:187], v[200:203], v[92:95]
    s_waitcnt vmcnt(18)
    v_mfma_f32_16x16x32_bf16 v[16:19], v[204:207], v[224:227], v[16:19]
    buffer_load_dwordx4 v[168:171], v4, s[12:15], s11 offen offset:2048
    v_mfma_f32_16x16x32_bf16 v[20:23], v[204:207], v[228:231], v[20:23]
    v_mfma_f32_16x16x32_bf16 v[24:27], v[204:207], v[232:235], v[24:27]
    buffer_load_dwordx4 v[172:175], v5, s[12:15], s11 offen offset:2048
    v_mfma_f32_16x16x32_bf16 v[28:31], v[204:207], v[236:239], v[28:31]
    v_mfma_f32_16x16x32_bf16 v[32:35], v[208:211], v[224:227], v[32:35]
    buffer_load_dwordx4 v[176:179], v6, s[12:15], s11 offen offset:2048
    v_mfma_f32_16x16x32_bf16 v[36:39], v[208:211], v[228:231], v[36:39]
    v_mfma_f32_16x16x32_bf16 v[40:43], v[208:211], v[232:235], v[40:43]
    buffer_load_dwordx4 v[180:183], v7, s[12:15], s11 offen offset:2048
    v_mfma_f32_16x16x32_bf16 v[44:47], v[208:211], v[236:239], v[44:47]
    v_mfma_f32_16x16x32_bf16 v[48:51], v[212:215], v[224:227], v[48:51]
    buffer_load_dwordx4 v[184:187], v8, s[12:15], s11 offen offset:2048
    v_mfma_f32_16x16x32_bf16 v[52:55], v[212:215], v[228:231], v[52:55]
    v_mfma_f32_16x16x32_bf16 v[56:59], v[212:215], v[232:235], v[56:59]
    buffer_load_dwordx4 v[188:191], v9, s[16:19], s11 offen offset:2048
    v_mfma_f32_16x16x32_bf16 v[60:63], v[212:215], v[236:239], v[60:63]
    v_mfma_f32_16x16x32_bf16 v[64:67], v[216:219], v[224:227], v[64:67]
    buffer_load_dwordx4 v[192:195], v10, s[16:19], s11 offen offset:2048
    v_mfma_f32_16x16x32_bf16 v[68:71], v[216:219], v[228:231], v[68:71]
    v_mfma_f32_16x16x32_bf16 v[72:75], v[216:219], v[232:235], v[72:75]
    buffer_load_dwordx4 v[196:199], v11, s[16:19], s11 offen offset:2048
    v_mfma_f32_16x16x32_bf16 v[76:79], v[216:219], v[236:239], v[76:79]
    v_mfma_f32_16x16x32_bf16 v[80:83], v[220:223], v[224:227], v[80:83]
    buffer_load_dwordx4 v[200:203], v12, s[16:19], s11 offen offset:2048
    v_mfma_f32_16x16x32_bf16 v[84:87], v[220:223], v[228:231], v[84:87]
    v_mfma_f32_16x16x32_bf16 v[88:91], v[220:223], v[232:235], v[88:91]
    v_mfma_f32_16x16x32_bf16 v[92:95], v[220:223], v[236:239], v[92:95]
    s_waitcnt vmcnt(18)
    v_mfma_f32_16x16x32_bf16 v[16:19], v[96:99], v[116:119], v[16:19]
    buffer_load_dwordx4 v[204:207], v4, s[12:15], s11 offen offset:3072
    v_mfma_f32_16x16x32_bf16 v[20:23], v[96:99], v[120:123], v[20:23]
    v_mfma_f32_16x16x32_bf16 v[24:27], v[96:99], v[124:127], v[24:27]
    buffer_load_dwordx4 v[208:211], v5, s[12:15], s11 offen offset:3072
    v_mfma_f32_16x16x32_bf16 v[28:31], v[96:99], v[128:131], v[28:31]
    v_mfma_f32_16x16x32_bf16 v[32:35], v[100:103], v[116:119], v[32:35]
    buffer_load_dwordx4 v[212:215], v6, s[12:15], s11 offen offset:3072
    v_mfma_f32_16x16x32_bf16 v[36:39], v[100:103], v[120:123], v[36:39]
    v_mfma_f32_16x16x32_bf16 v[40:43], v[100:103], v[124:127], v[40:43]
    buffer_load_dwordx4 v[216:219], v7, s[12:15], s11 offen offset:3072
    v_mfma_f32_16x16x32_bf16 v[44:47], v[100:103], v[128:131], v[44:47]
    v_mfma_f32_16x16x32_bf16 v[48:51], v[104:107], v[116:119], v[48:51]
    buffer_load_dwordx4 v[220:223], v8, s[12:15], s11 offen offset:3072
    v_mfma_f32_16x16x32_bf16 v[52:55], v[104:107], v[120:123], v[52:55]
    v_mfma_f32_16x16x32_bf16 v[56:59], v[104:107], v[124:127], v[56:59]
    buffer_load_dwordx4 v[224:227], v9, s[16:19], s11 offen offset:3072
    v_mfma_f32_16x16x32_bf16 v[60:63], v[104:107], v[128:131], v[60:63]
    v_mfma_f32_16x16x32_bf16 v[64:67], v[108:111], v[116:119], v[64:67]
    buffer_load_dwordx4 v[228:231], v10, s[16:19], s11 offen offset:3072
    v_mfma_f32_16x16x32_bf16 v[68:71], v[108:111], v[120:123], v[68:71]
    v_mfma_f32_16x16x32_bf16 v[72:75], v[108:111], v[124:127], v[72:75]
    buffer_load_dwordx4 v[232:235], v11, s[16:19], s11 offen offset:3072
    v_mfma_f32_16x16x32_bf16 v[76:79], v[108:111], v[128:131], v[76:79]
    v_mfma_f32_16x16x32_bf16 v[80:83], v[112:115], v[116:119], v[80:83]
    buffer_load_dwordx4 v[236:239], v12, s[16:19], s11 offen offset:3072
    v_mfma_f32_16x16x32_bf16 v[84:87], v[112:115], v[120:123], v[84:87]
    v_mfma_f32_16x16x32_bf16 v[88:91], v[112:115], v[124:127], v[88:91]
    v_mfma_f32_16x16x32_bf16 v[92:95], v[112:115], v[128:131], v[92:95]
    s_waitcnt vmcnt(18)
    v_mfma_f32_16x16x32_bf16 v[16:19], v[132:135], v[152:155], v[16:19]
    s_add_u32 s11, s11, 4096
    buffer_load_dwordx4 v[96:99], v4, s[12:15], s11 offen offset:0
    v_mfma_f32_16x16x32_bf16 v[20:23], v[132:135], v[156:159], v[20:23]
    v_mfma_f32_16x16x32_bf16 v[24:27], v[132:135], v[160:163], v[24:27]
    buffer_load_dwordx4 v[100:103], v5, s[12:15], s11 offen offset:0
    v_mfma_f32_16x16x32_bf16 v[28:31], v[132:135], v[164:167], v[28:31]
    v_mfma_f32_16x16x32_bf16 v[32:35], v[136:139], v[152:155], v[32:35]
    buffer_load_dwordx4 v[104:107], v6, s[12:15], s11 offen offset:0
    v_mfma_f32_16x16x32_bf16 v[36:39], v[136:139], v[156:159], v[36:39]
    v_mfma_f32_16x16x32_bf16 v[40:43], v[136:139], v[160:163], v[40:43]
    buffer_load_dwordx4 v[108:111], v7, s[12:15], s11 offen offset:0
    v_mfma_f32_16x16x32_bf16 v[44:47], v[136:139], v[164:167], v[44:47]
    v_mfma_f32_16x16x32_bf16 v[48:51], v[140:143], v[152:155], v[48:51]
    buffer_load_dwordx4 v[112:115], v8, s[12:15], s11 offen offset:0
    v_mfma_f32_16x16x32_bf16 v[52:55], v[140:143], v[156:159], v[52:55]
    v_mfma_f32_16x16x32_bf16 v[56:59], v[140:143], v[160:163], v[56:59]
    buffer_load_dwordx4 v[116:119], v9, s[16:19], s11 offen offset:0
    v_mfma_f32_16x16x32_bf16 v[60:63], v[140:143], v[164:167], v[60:63]
    v_mfma_f32_16x16x32_bf16 v[64:67], v[144:147], v[152:155], v[64:67]
    buffer_load_dwordx4 v[120:123], v10, s[16:19], s11 offen offset:0
    v_mfma_f32_16x16x32_bf16 v[68:71], v[144:147], v[156:159], v[68:71]
    v_mfma_f32_16x16x32_bf16 v[72:75], v[144:147], v[160:163], v[72:75]
    buffer_load_dwordx4 v[124:127], v11, s[16:19], s11 offen offset:0
    v_mfma_f32_16x16x32_bf16 v[76:79], v[144:147], v[164:167], v[76:79]
    v_mfma_f32_16x16x32_bf16 v[80:83], v[148:151], v[152:155], v[80:83]
    buffer_load_dwordx4 v[128:131], v12, s[16:19], s11 offen offset:0
    v_mfma_f32_16x16x32_bf16 v[84:87], v[148:151], v[156:159], v[84:87]
    v_mfma_f32_16x16x32_bf16 v[88:91], v[148:151], v[160:163], v[88:91]
    v_mfma_f32_16x16x32_bf16 v[92:95], v[148:151], v[164:167], v[92:95]
    s_waitcnt vmcnt(18)
    v_mfma_f32_16x16x32_bf16 v[16:19], v[168:171], v[188:191], v[16:19]
    buffer_load_dwordx4 v[132:135], v4, s[12:15], s11 offen offset:1024
    v_mfma_f32_16x16x32_bf16 v[20:23], v[168:171], v[192:195], v[20:23]
    v_mfma_f32_16x16x32_bf16 v[24:27], v[168:171], v[196:199], v[24:27]
    buffer_load_dwordx4 v[136:139], v5, s[12:15], s11 offen offset:1024
    v_mfma_f32_16x16x32_bf16 v[28:31], v[168:171], v[200:203], v[28:31]
    v_mfma_f32_16x16x32_bf16 v[32:35], v[172:175], v[188:191], v[32:35]
    buffer_load_dwordx4 v[140:143], v6, s[12:15], s11 offen offset:1024
    v_mfma_f32_16x16x32_bf16 v[36:39], v[172:175], v[192:195], v[36:39]
    v_mfma_f32_16x16x32_bf16 v[40:43], v[172:175], v[196:199], v[40:43]
    buffer_load_dwordx4 v[144:147], v7, s[12:15], s11 offen offset:1024
    v_mfma_f32_16x16x32_bf16 v[44:47], v[172:175], v[200:203], v[44:47]
    v_mfma_f32_16x16x32_bf16 v[48:51], v[176:179], v[188:191], v[48:51]
    buffer_load_dwordx4 v[148:151], v8, s[12:15], s11 offen offset:1024
    v_mfma_f32_16x16x32_bf16 v[52:55], v[176:179], v[192:195], v[52:55]
    v_mfma_f32_16x16x32_bf16 v[56:59], v[176:179], v[196:199], v[56:59]
    buffer_load_dwordx4 v[152:155], v9, s[16:19], s11 offen offset:1024
    v_mfma_f32_16x16x32_bf16 v[60:63], v[176:179], v[200:203], v[60:63]
    v_mfma_f32_16x16x32_bf16 v[64:67], v[180:183], v[188:191], v[64:67]
    buffer_load_dwordx4 v[156:159], v10, s[16:19], s11 offen offset:1024
    v_mfma_f32_16x16x32_bf16 v[68:71], v[180:183], v[192:195], v[68:71]
    v_mfma_f32_16x16x32_bf16 v[72:75], v[180:183], v[196:199], v[72:75]
    buffer_load_dwordx4 v[160:163], v11, s[16:19], s11 offen offset:1024
    v_mfma_f32_16x16x32_bf16 v[76:79], v[180:183], v[200:203], v[76:79]
    v_mfma_f32_16x16x32_bf16 v[80:83], v[184:187], v[188:191], v[80:83]
    buffer_load_dwordx4 v[164:167], v12, s[16:19], s11 offen offset:1024
    v_mfma_f32_16x16x32_bf16 v[84:87], v[184:187], v[192:195], v[84:87]
    v_mfma_f32_16x16x32_bf16 v[88:91], v[184:187], v[196:199], v[88:91]
    v_mfma_f32_16x16x32_bf16 v[92:95], v[184:187], v[200:203], v[92:95]
    s_waitcnt vmcnt(18)
    v_mfma_f32_16x16x32_bf16 v[16:19], v[204:207], v[224:227], v[16:19]
    v_mfma_f32_16x16x32_bf16 v[20:23], v[204:207], v[228:231], v[20:23]
    v_mfma_f32_16x16x32_bf16 v[24:27], v[204:207], v[232:235], v[24:27]
    v_mfma_f32_16x16x32_bf16 v[28:31], v[204:207], v[236:239], v[28:31]
    v_mfma_f32_16x16x32_bf16 v[32:35], v[208:211], v[224:227], v[32:35]
    v_mfma_f32_16x16x32_bf16 v[36:39], v[208:211], v[228:231], v[36:39]
    v_mfma_f32_16x16x32_bf16 v[40:43], v[208:211], v[232:235], v[40:43]
    v_mfma_f32_16x16x32_bf16 v[44:47], v[208:211], v[236:239], v[44:47]
    v_mfma_f32_16x16x32_bf16 v[48:51], v[212:215], v[224:227], v[48:51]
    v_mfma_f32_16x16x32_bf16 v[52:55], v[212:215], v[228:231], v[52:55]
    v_mfma_f32_16x16x32_bf16 v[56:59], v[212:215], v[232:235], v[56:59]
    v_mfma_f32_16x16x32_bf16 v[60:63], v[212:215], v[236:239], v[60:63]
    v_mfma_f32_16x16x32_bf16 v[64:67], v[216:219], v[224:227], v[64:67]
    v_mfma_f32_16x16x32_bf16 v[68:71], v[216:219], v[228:231], v[68:71]
    v_mfma_f32_16x16x32_bf16 v[72:75], v[216:219], v[232:235], v[72:75]
    v_mfma_f32_16x16x32_bf16 v[76:79], v[216:219], v[236:239], v[76:79]
    v_mfma_f32_16x16x32_bf16 v[80:83], v[220:223], v[224:227], v[80:83]
    v_mfma_f32_16x16x32_bf16 v[84:87], v[220:223], v[228:231], v[84:87]
    v_mfma_f32_16x16x32_bf16 v[88:91], v[220:223], v[232:235], v[88:91]
    v_mfma_f32_16x16x32_bf16 v[92:95], v[220:223], v[236:239], v[92:95]
    s_waitcnt vmcnt(9)
    v_mfma_f32_16x16x32_bf16 v[16:19], v[96:99], v[116:119], v[16:19]
    v_mfma_f32_16x16x32_bf16 v[20:23], v[96:99], v[120:123], v[20:23]
    v_mfma_f32_16x16x32_bf16 v[24:27], v[96:99], v[124:127], v[24:27]
    v_mfma_f32_16x16x32_bf16 v[28:31], v[96:99], v[128:131], v[28:31]
    v_mfma_f32_16x16x32_bf16 v[32:35], v[100:103], v[116:119], v[32:35]
    v_mfma_f32_16x16x32_bf16 v[36:39], v[100:103], v[120:123], v[36:39]
    v_mfma_f32_16x16x32_bf16 v[40:43], v[100:103], v[124:127], v[40:43]
    v_mfma_f32_16x16x32_bf16 v[44:47], v[100:103], v[128:131], v[44:47]
    v_mfma_f32_16x16x32_bf16 v[48:51], v[104:107], v[116:119], v[48:51]
    v_mfma_f32_16x16x32_bf16 v[52:55], v[104:107], v[120:123], v[52:55]
    v_mfma_f32_16x16x32_bf16 v[56:59], v[104:107], v[124:127], v[56:59]
    v_mfma_f32_16x16x32_bf16 v[60:63], v[104:107], v[128:131], v[60:63]
    v_mfma_f32_16x16x32_bf16 v[64:67], v[108:111], v[116:119], v[64:67]
    v_mfma_f32_16x16x32_bf16 v[68:71], v[108:111], v[120:123], v[68:71]
    v_mfma_f32_16x16x32_bf16 v[72:75], v[108:111], v[124:127], v[72:75]
    v_mfma_f32_16x16x32_bf16 v[76:79], v[108:111], v[128:131], v[76:79]
    v_mfma_f32_16x16x32_bf16 v[80:83], v[112:115], v[116:119], v[80:83]
    v_mfma_f32_16x16x32_bf16 v[84:87], v[112:115], v[120:123], v[84:87]
    v_mfma_f32_16x16x32_bf16 v[88:91], v[112:115], v[124:127], v[88:91]
    v_mfma_f32_16x16x32_bf16 v[92:95], v[112:115], v[128:131], v[92:95]
    s_waitcnt vmcnt(0)
    s_cmp_ge_u32 s6, 2
    s_cbranch_scc1 L_kd_skip
    v_mfma_f32_16x16x32_bf16 v[16:19], v[132:135], v[152:155], v[16:19]
    v_mfma_f32_16x16x32_bf16 v[20:23], v[132:135], v[156:159], v[20:23]
    v_mfma_f32_16x16x32_bf16 v[24:27], v[132:135], v[160:163], v[24:27]
    v_mfma_f32_16x16x32_bf16 v[28:31], v[132:135], v[164:167], v[28:31]
    v_mfma_f32_16x16x32_bf16 v[32:35], v[136:139], v[152:155], v[32:35]
    v_mfma_f32_16x16x32_bf16 v[36:39], v[136:139], v[156:159], v[36:39]
    v_mfma_f32_16x16x32_bf16 v[40:43], v[136:139], v[160:163], v[40:43]
    v_mfma_f32_16x16x32_bf16 v[44:47], v[136:139], v[164:167], v[44:47]
    v_mfma_f32_16x16x32_bf16 v[48:51], v[140:143], v[152:155], v[48:51]
    v_mfma_f32_16x16x32_bf16 v[52:55], v[140:143], v[156:159], v[52:55]
    v_mfma_f32_16x16x32_bf16 v[56:59], v[140:143], v[160:163], v[56:59]
    v_mfma_f32_16x16x32_bf16 v[60:63], v[140:143], v[164:167], v[60:63]
    v_mfma_f32_16x16x32_bf16 v[64:67], v[144:147], v[152:155], v[64:67]
    v_mfma_f32_16x16x32_bf16 v[68:71], v[144:147], v[156:159], v[68:71]
    v_mfma_f32_16x16x32_bf16 v[72:75], v[144:147], v[160:163], v[72:75]
    v_mfma_f32_16x16x32_bf16 v[76:79], v[144:147], v[164:167], v[76:79]
    v_mfma_f32_16x16x32_bf16 v[80:83], v[148:151], v[152:155], v[80:83]
    v_mfma_f32_16x16x32_bf16 v[84:87], v[148:151], v[156:159], v[84:87]
    v_mfma_f32_16x16x32_bf16 v[88:91], v[148:151], v[160:163], v[88:91]
    v_mfma_f32_16x16x32_bf16 v[92:95], v[148:151], v[164:167], v[92:95]
L_kd_skip:
    s_nop 7
    buffer_load_dwordx2 v[96:97], v13, s[20:23], 0 offen offset:0
    buffer_load_dwordx2 v[98:99], v13, s[20:23], 0 offen offset:32
    buffer_load_dwordx2 v[100:101], v13, s[20:23], 0 offen offset:64
    buffer_load_dwordx2 v[102:103], v13, s[20:23], 0 offen offset:96
    buffer_load_dwordx2 v[104:105], v13, s[20:23], 0 offen offset:128
    s_add_u32 s32, s6, 1
    s_and_b32 s32, s32, 3
    s_mul_i32 s32, s32, 15360
    v_add_u32 v14, s32, v3
    ds_write_b128 v14, v[20:23] offset:0
    ds_write_b128 v14, v[36:39] offset:1024
    ds_write_b128 v14, v[52:55] offset:2048
    ds_write_b128 v14, v[68:71] offset:3072
    ds_write_b128 v14, v[84:87] offset:4096
    s_add_u32 s32, s6, 2
    s_and_b32 s32, s32, 3
    s_mul_i32 s32, s32, 15360
    v_add_u32 v14, s32, v3
    ds_write_b128 v14, v[24:27] offset:5120
    ds_write_b128 v14, v[40:43] offset:6144
    ds_write_b128 v14, v[56:59] offset:7168
    ds_write_b128 v14, v[72:75] offset:8192
    ds_write_b128 v14, v[88:91] offset:9216
    s_add_u32 s32, s6, 3
    s_and_b32 s32, s32, 3
    s_mul_i32 s32, s32, 15360
    v_add_u32 v14, s32, v3
    ds_write_b128 v14, v[28:31] offset:10240
    ds_write_b128 v14, v[44:47] offset:11264
    ds_write_b128 v14, v[60:63] offset:12288
    ds_write_b128 v14, v[76:79] offset:13312
    ds_write_b128 v14, v[92:95] offset:14336
    s_mul_i32 s32, s6, 15360
    v_add_u32 v14, s32, v3
    s_waitcnt lgkmcnt(0)
    s_barrier
    ds_read_b128 v[112:115], v14 offset:0
    ds_read_b128 v[116:119], v14 offset:1024
    ds_read_b128 v[120:123], v14 offset:2048
    ds_read_b128 v[124:127], v14 offset:3072
    ds_read_b128 v[128:131], v14 offset:4096
    ds_read_b128 v[132:135], v14 offset:5120
    ds_read_b128 v[136:139], v14 offset:6144
    ds_read_b128 v[140:143], v14 offset:7168
    ds_read_b128 v[144:147], v14 offset:8192
    ds_read_b128 v[148:151], v14 offset:9216
    ds_read_b128 v[152:155], v14 offset:10240
    ds_read_b128 v[156:159], v14 offset:11264
    ds_read_b128 v[160:163], v14 offset:12288
    ds_read_b128 v[164:167], v14 offset:13312
    ds_read_b128 v[168:171], v14 offset:14336
    s_waitcnt lgkmcnt(10)
    v_pk_add_f32 v[16:17], v[16:17], v[112:113]
    v_pk_add_f32 v[18:19], v[18:19], v[114:115]
    v_pk_add_f32 v[32:33], v[32:33], v[116:117]
    v_pk_add_f32 v[34:35], v[34:35], v[118:119]
    v_pk_add_f32 v[48:49], v[48:49], v[120:121]
    v_pk_add_f32 v[50:51], v[50:51], v[122:123]
    v_pk_add_f32 v[64:65], v[64:65], v[124:125]
    v_pk_add_f32 v[66:67], v[66:67], v[126:127]
    v_pk_add_f32 v[80:81], v[80:81], v[128:129]
    v_pk_add_f32 v[82:83], v[82:83], v[130:131]
    s_waitcnt lgkmcnt(5)
    v_pk_add_f32 v[16:17], v[16:17], v[132:133]
    v_pk_add_f32 v[18:19], v[18:19], v[134:135]
    v_pk_add_f32 v[32:33], v[32:33], v[136:137]
    v_pk_add_f32 v[34:35], v[34:35], v[138:139]
    v_pk_add_f32 v[48:49], v[48:49], v[140:141]
    v_pk_add_f32 v[50:51], v[50:51], v[142:143]
    v_pk_add_f32 v[64:65], v[64:65], v[144:145]
    v_pk_add_f32 v[66:67], v[66:67], v[146:147]
    v_pk_add_f32 v[80:81], v[80:81], v[148:149]
    v_pk_add_f32 v[82:83], v[82:83], v[150:151]
    s_waitcnt lgkmcnt(0)
    v_pk_add_f32 v[16:17], v[16:17], v[152:153]
    v_pk_add_f32 v[18:19], v[18:19], v[154:155]
    v_pk_add_f32 v[32:33], v[32:33], v[156:157]
    v_pk_add_f32 v[34:35], v[34:35], v[158:159]
    v_pk_add_f32 v[48:49], v[48:49], v[160:161]
    v_pk_add_f32 v[50:51], v[50:51], v[162:163]
    v_pk_add_f32 v[64:65], v[64:65], v[164:165]
    v_pk_add_f32 v[66:67], v[66:67], v[166:167]
    v_pk_add_f32 v[80:81], v[80:81], v[168:169]
    v_pk_add_f32 v[82:83], v[82:83], v[170:171]
    s_waitcnt vmcnt(0)
    v_cvt_pk_bf16_f32 v112, v16, v17
    v_cvt_pk_bf16_f32 v113, v18, v19
    v_lshlrev_b32 v114, 16, v112
    v_and_b32 v115, 0xffff0000, v112
    v_lshlrev_b32 v116, 16, v113
    v_and_b32 v117, 0xffff0000, v113
    v_lshlrev_b32 v16, 16, v96
    v_and_b32 v17, 0xffff0000, v96
    v_lshlrev_b32 v18, 16, v97
    v_and_b32 v19, 0xffff0000, v97
    v_add_f32 v16, v16, v114
    v_add_f32 v17, v17, v115
    v_add_f32 v18, v18, v116
    v_add_f32 v19, v19, v117
    v_cvt_pk_bf16_f32 v112, v16, v17
    v_cvt_pk_bf16_f32 v113, v18, v19
    buffer_store_dwordx2 v[112:113], v13, s[24:27], 0 offen offset:0
    v_cvt_pk_bf16_f32 v120, v32, v33
    v_cvt_pk_bf16_f32 v121, v34, v35
    v_lshlrev_b32 v122, 16, v120
    v_and_b32 v123, 0xffff0000, v120
    v_lshlrev_b32 v124, 16, v121
    v_and_b32 v125, 0xffff0000, v121
    v_lshlrev_b32 v32, 16, v98
    v_and_b32 v33, 0xffff0000, v98
    v_lshlrev_b32 v34, 16, v99
    v_and_b32 v35, 0xffff0000, v99
    v_add_f32 v32, v32, v122
    v_add_f32 v33, v33, v123
    v_add_f32 v34, v34, v124
    v_add_f32 v35, v35, v125
    v_cvt_pk_bf16_f32 v120, v32, v33
    v_cvt_pk_bf16_f32 v121, v34, v35
    buffer_store_dwordx2 v[120:121], v13, s[24:27], 0 offen offset:32
    v_cvt_pk_bf16_f32 v128, v48, v49
    v_cvt_pk_bf16_f32 v129, v50, v51
    v_lshlrev_b32 v130, 16, v128
    v_and_b32 v131, 0xffff0000, v128
    v_lshlrev_b32 v132, 16, v129
    v_and_b32 v133, 0xffff0000, v129
    v_lshlrev_b32 v48, 16, v100
    v_and_b32 v49, 0xffff0000, v100
    v_lshlrev_b32 v50, 16, v101
    v_and_b32 v51, 0xffff0000, v101
    v_add_f32 v48, v48, v130
    v_add_f32 v49, v49, v131
    v_add_f32 v50, v50, v132
    v_add_f32 v51, v51, v133
    v_cvt_pk_bf16_f32 v128, v48, v49
    v_cvt_pk_bf16_f32 v129, v50, v51
    buffer_store_dwordx2 v[128:129], v13, s[24:27], 0 offen offset:64
    v_cvt_pk_bf16_f32 v136, v64, v65
    v_cvt_pk_bf16_f32 v137, v66, v67
    v_lshlrev_b32 v138, 16, v136
    v_and_b32 v139, 0xffff0000, v136
    v_lshlrev_b32 v140, 16, v137
    v_and_b32 v141, 0xffff0000, v137
    v_lshlrev_b32 v64, 16, v102
    v_and_b32 v65, 0xffff0000, v102
    v_lshlrev_b32 v66, 16, v103
    v_and_b32 v67, 0xffff0000, v103
    v_add_f32 v64, v64, v138
    v_add_f32 v65, v65, v139
    v_add_f32 v66, v66, v140
    v_add_f32 v67, v67, v141
    v_cvt_pk_bf16_f32 v136, v64, v65
    v_cvt_pk_bf16_f32 v137, v66, v67
    buffer_store_dwordx2 v[136:137], v13, s[24:27], 0 offen offset:96
    v_cvt_pk_bf16_f32 v144, v80, v81
    v_cvt_pk_bf16_f32 v145, v82, v83
    v_lshlrev_b32 v146, 16, v144
    v_and_b32 v147, 0xffff0000, v144
    v_lshlrev_b32 v148, 16, v145
    v_and_b32 v149, 0xffff0000, v145
    v_lshlrev_b32 v80, 16, v104
    v_and_b32 v81, 0xffff0000, v104
    v_lshlrev_b32 v82, 16, v105
    v_and_b32 v83, 0xffff0000, v105
    v_add_f32 v80, v80, v146
    v_add_f32 v81, v81, v147
    v_add_f32 v82, v82, v148
    v_add_f32 v83, v83, v149
    v_cvt_pk_bf16_f32 v144, v80, v81
    v_cvt_pk_bf16_f32 v145, v82, v83
    buffer_store_dwordx2 v[144:145], v13, s[24:27], 0 offen offset:128
L_kd_end:
    s_endpgm
.section .rodata,"a"
.p2align 6
.amdhsa_kernel ka_kernel
  .amdhsa_next_free_vgpr 136
  .amdhsa_next_free_sgpr 96
  .amdhsa_accum_offset 136
  .amdhsa_group_segment_fixed_size 0
  .amdhsa_kernarg_size 96
  .amdhsa_user_sgpr_count 2
  .amdhsa_user_sgpr_kernarg_segment_ptr 1
  .amdhsa_system_sgpr_workgroup_id_x 1
  .amdhsa_float_denorm_mode_32 3
  .amdhsa_float_denorm_mode_16_64 3
.end_amdhsa_kernel
.p2align 6
.amdhsa_kernel kb_kernel
  .amdhsa_next_free_vgpr 224
  .amdhsa_next_free_sgpr 96
  .amdhsa_accum_offset 224
  .amdhsa_group_segment_fixed_size 0
  .amdhsa_kernarg_size 96
  .amdhsa_user_sgpr_count 2
  .amdhsa_user_sgpr_kernarg_segment_ptr 1
  .amdhsa_system_sgpr_workgroup_id_x 1
  .amdhsa_float_denorm_mode_32 3
  .amdhsa_float_denorm_mode_16_64 3
.end_amdhsa_kernel
.p2align 6
.amdhsa_kernel kc_kernel
  .amdhsa_next_free_vgpr 372
  .amdhsa_next_free_sgpr 96
  .amdhsa_accum_offset 212
  .amdhsa_group_segment_fixed_size 0
  .amdhsa_kernarg_size 96
  .amdhsa_user_sgpr_count 2
  .amdhsa_user_sgpr_kernarg_segment_ptr 1
  .amdhsa_system_sgpr_workgroup_id_x 1
  .amdhsa_float_denorm_mode_32 3
  .amdhsa_float_denorm_mode_16_64 3
.end_amdhsa_kernel
.p2align 6
.amdhsa_kernel kd_kernel
  .amdhsa_next_free_vgpr 240
  .amdhsa_next_free_sgpr 96
  .amdhsa_accum_offset 240
  .amdhsa_group_segment_fixed_size 0
  .amdhsa_kernarg_size 96
  .amdhsa_user_sgpr_count 2
  .amdhsa_user_sgpr_kernarg_segment_ptr 1
  .amdhsa_system_sgpr_workgroup_id_x 1
  .amdhsa_float_denorm_mode_32 3
  .amdhsa_float_denorm_mode_16_64 3
.end_amdhsa_kernel
```
